```python
import torch

def _softmax(x, axis=-1):
    return torch.softmax(x, dim=axis)
def _gelu(x):
    return torch.nn.functional.gelu(x, approximate="tanh")
def _silu(x):
    return torch.nn.functional.silu(x)
def _sigmoid(x):
    return torch.sigmoid(x)
def _layernorm(x, axis=-1, eps=1e-5):
    m = x.mean(dim=axis, keepdim=True)
    v = x.var(dim=axis, keepdim=True, unbiased=False)
    return (x - m) / torch.sqrt(v + eps)
def _scatter_add(tgt, idx, src, axis=0):
    return tgt.clone().index_add_(axis, idx, src)
def _segment_sum(src, seg, n):
    out = torch.zeros((n,) + src.shape[1:], dtype=src.dtype)
    return out.index_add_(0, seg, src)
def _pad(x, pw):
    flat = tuple(v for pair in reversed(pw) for v in pair)
    return torch.nn.functional.pad(x, flat)

kernel_name = 'parallel_sum__grouped_kv_mqa__glu_gated_geglu__prompt'

def setup_inputs():

    _w = (lambda a: (lambda t: t.to(torch.bfloat16) if t.is_floating_point() else t)(torch.as_tensor(a)))
    def _A_setup():
        B, S, D, H = 1, 2048, 512, 32
        Dh = D // H
        return {
            "x": _w((lambda *s: torch.randn(*s, dtype=torch.bfloat16) * 0.05)(B, S, D)),
            "wq": _w((lambda *s: torch.randn(*s, dtype=torch.bfloat16) * 0.05)(D, H * Dh)),
            "wk": _w((lambda *s: torch.randn(*s, dtype=torch.bfloat16) * 0.05)(D, Dh)),
            "wv": _w((lambda *s: torch.randn(*s, dtype=torch.bfloat16) * 0.05)(D, Dh)),
            "wo": _w((lambda *s: torch.randn(*s, dtype=torch.bfloat16) * 0.05)(H * Dh, D)),
        }
    _A_in = _A_setup()

    def _B_setup():
        B, S, Dm, Df = 1, 2048, 512, 1792
        return {
            "x": _w((lambda *s: torch.randn(*s, dtype=torch.bfloat16) * 0.05)(B, S, Dm)),
            "w_gate": _w((lambda *s: torch.randn(*s, dtype=torch.bfloat16) * 0.4)(Dm, Df) * (Dm ** -0.5)),
            "w_up": _w((lambda *s: torch.randn(*s, dtype=torch.bfloat16) * 0.4)(Dm, Df) * (Dm ** -0.5)),
            "w_down": _w((lambda *s: torch.randn(*s, dtype=torch.bfloat16) * 0.4)(Df, Dm) * (Df ** -0.5)),
        }
    _B_in = _B_setup()

    return {
        "A_x": _A_in["x"],
        "A_wq": _A_in["wq"],
        "A_wk": _A_in["wk"],
        "A_wv": _A_in["wv"],
        "A_wo": _A_in["wo"],
        "B_x": _B_in["x"],
        "B_w_gate": _B_in["w_gate"],
        "B_w_up": _B_in["w_up"],
        "B_w_down": _B_in["w_down"],
    }

def reference(A_x, A_wq, A_wk, A_wv, A_wo, B_x, B_w_gate, B_w_up, B_w_down):
    def _A_ref(x, wq, wk, wv, wo):
        B, S, D = x.shape
        H = 32
        Dh = D // H
        q = (lambda x, *d: x.permute(*d))((x @ wq).reshape(B, S, H, Dh), 0, 2, 1, 3)
        k = x @ wk
        v = x @ wv
        scores = torch.einsum("bhqd,bkd->bhqk", q, k) * (Dh ** -0.5)
        p = _softmax(scores, axis=-1)
        o = torch.einsum("bhqk,bkd->bhqd", p, v)
        return (lambda x, *d: x.permute(*d))(o, 0, 2, 1, 3).reshape(B, S, H * Dh) @ wo

    def _B_ref(x, w_gate, w_up, w_down):
        g = torch.einsum("bsd,df->bsf", x, w_gate)
        u = torch.einsum("bsd,df->bsf", x, w_up)
        h = _gelu(g) * u
        return torch.einsum("bsf,fd->bsd", h, w_down)

    x = A_x
    xn = _layernorm(x, axis=-1)
    return x + _A_ref(xn, A_wq, A_wk, A_wv, A_wo) + _B_ref(xn, B_w_gate, B_w_up, B_w_down)
```

```asm
; @launch grid=(512,1,1) block=(512,1,1) lds=81920
.amdgcn_target "amdgcn-amd-amdhsa--gfx950"
.text
.globl parallel_sum__grouped_kv_mqa__glu_gated_geglu__prompt_kernel
.p2align 8
.type parallel_sum__grouped_kv_mqa__glu_gated_geglu__prompt_kernel,@function
parallel_sum__grouped_kv_mqa__glu_gated_geglu__prompt_kernel:
    s_cmp_ge_u32 s2, 512
    s_cbranch_scc1 m_end
    s_xor_b32 s2, s2, 256
    s_load_dwordx2 s[4:5], s[0:1], 0
    s_load_dwordx2 s[6:7], s[0:1], 8
    s_load_dwordx4 s[8:11], s[0:1], 16
    s_load_dwordx4 s[12:15], s[0:1], 80
    v_and_b32 v1, 63, v0
    v_lshrrev_b32 v5, 6, v0
    s_cmp_lt_u32 s2, 256
    v_readfirstlane_b32 s3, v5
    s_cselect_b32 s41, 3, 4
    s_cselect_b32 s42, 7, 15
    s_cselect_b32 s43, 7, 8
    s_cselect_b32 s44, 31, 63
    s_cselect_b32 s45, 16, 15
    s_cselect_b32 s46, 13, 12
    s_lshl_b32 s43, 1, s43
    s_and_b32 s37, s2, s44
    s_lshl_b32 s38, s37, s45
    s_lshl_b32 s39, s3, s46
    s_add_u32 s38, s38, s39
    v_lshrrev_b32 v4, s41, v1
    v_and_b32 v5, s42, v1
    v_lshlrev_b32 v7, 10, v4
    v_lshl_add_u32 v7, v5, 4, v7
    s_mov_b32 s18, 2097152
    s_mov_b32 s19, 0x00020000
    s_waitcnt lgkmcnt(0)
    s_mov_b32 s16, s4
    s_and_b32 s17, s5, 0xffff
    s_cmp_gt_u32 s2, 447
    s_cbranch_scc1 m_nox
    buffer_load_dwordx4 v[8:11], v7, s[16:19], s38 offen
    s_add_u32 s38, s38, s43
    buffer_load_dwordx4 v[12:15], v7, s[16:19], s38 offen
    s_add_u32 s38, s38, s43
    buffer_load_dwordx4 v[16:19], v7, s[16:19], s38 offen
    s_add_u32 s38, s38, s43
    buffer_load_dwordx4 v[20:23], v7, s[16:19], s38 offen
    s_add_u32 s38, s38, s43
    m_nox:
    v_and_b32 v2, 31, v0
    v_bfe_u32 v3, v0, 5, 1
    v_lshlrev_b32 v6, 4, v1
    s_mov_b32 s46, s12
    s_mov_b32 s47, s13
    s_mov_b32 s12, s14
    s_mov_b32 s13, s15
    s_mov_b32 s14, s46
    s_mov_b32 s15, s47
    s_cmp_lt_u32 s2, 256
    s_cbranch_scc1 m_att
    s_cmp_gt_u32 s2, 447
    s_cbranch_scc1 m_gsleep
    s_setprio 3
    s_xor_b32 s46, s2, 256
    s_or_b32 s46, s46, s3
    s_cmp_lg_u32 s46, 0
    s_cbranch_scc1 m_noep
    s_memrealtime s[46:47]
    v_mov_b32 v40, 0
    s_waitcnt lgkmcnt(0)
    v_mov_b32 v42, s46
    v_mov_b32 v43, s47
    s_mov_b64 exec, 1
    global_store_dwordx2 v40, v[42:43], s[14:15] sc1
    s_mov_b64 exec, -1
    m_noep:
    s_sub_u32 s36, s2, 256
    s_lshr_b32 s36, s36, 6
    s_cmp_eq_u32 s36, 1
    s_cselect_b32 s24, s10, s8
    s_cselect_b32 s25, s11, s9
    s_and_b32 s25, s25, 0xffff
    s_mov_b32 s26, 16384
    s_mov_b32 s27, 0x00020000
    s_lshl_b32 s43, s3, 11
    s_add_u32 m0, s43, 32768
    s_add_u32 s41, s43, 1024
    buffer_load_dwordx4 v6, s[24:27], s43 offen lds
    s_add_u32 m0, s43, 33792
    s_nop 0
    buffer_load_dwordx4 v6, s[24:27], s41 offen lds
    s_lshl_b32 s41, s3, 2
    v_add_u32 v40, s41, v4
    v_and_b32 v41, 7, v5
    v_xor_b32 v40, v40, v41
    v_lshlrev_b32 v40, 4, v40
    v_lshrrev_b32 v41, 1, v5
    v_lshl_add_u32 v40, v41, 10, v40
    v_and_b32 v41, 1, v5
    v_lshl_add_u32 v60, v41, 9, v40
    v_xor_b32 v40, v2, v3
    v_lshlrev_b32 v40, 4, v40
    v_lshl_add_u32 v40, v3, 9, v40
    s_lshl_b32 s41, s3, 12
    v_add_u32 v61, s41, v40
    v_xor_b32 v62, 32, v61
    v_xor_b32 v63, 64, v61
    v_xor_b32 v64, 96, v61
    v_bfe_u32 v40, v1, 2, 2
    v_lshl_add_u32 v40, v3, 3, v40
    v_lshlrev_b32 v40, 5, v40
    v_and_b32 v41, 3, v1
    v_lshl_add_u32 v40, v41, 3, v40
    s_lshl_b32 s41, s3, 11
    s_add_u32 s41, s41, 32768
    v_add_u32 v65, s41, v40
    v_mov_b32 v56, 0x3f803f80
    v_mov_b32 v57, 0
    s_waitcnt vmcnt(2)
    s_cmp_lg_u32 s3, 0
    s_cbranch_scc1 m_eed_1
    v_mov_b32 v126, 0
    global_load_dwordx2 v[124:125], v126, s[14:15] sc1
m_eed_1:
    v_dot2c_f32_bf16 v57, v8, v56
    v_dot2c_f32_bf16 v57, v9, v56
    v_dot2c_f32_bf16 v57, v10, v56
    v_dot2c_f32_bf16 v57, v11, v56
    v_dot2c_f32_bf16 v57, v12, v56
    v_dot2c_f32_bf16 v57, v13, v56
    v_dot2c_f32_bf16 v57, v14, v56
    v_dot2c_f32_bf16 v57, v15, v56
    v_dot2c_f32_bf16 v57, v16, v56
    v_dot2c_f32_bf16 v57, v17, v56
    v_dot2c_f32_bf16 v57, v18, v56
    v_dot2c_f32_bf16 v57, v19, v56
    v_dot2c_f32_bf16 v57, v20, v56
    v_dot2c_f32_bf16 v57, v21, v56
    v_dot2c_f32_bf16 v57, v22, v56
    v_dot2c_f32_bf16 v57, v23, v56
    v_lshlrev_b32 v24, 16, v8
    v_and_b32 v25, 0xffff0000, v8
    v_lshlrev_b32 v26, 16, v9
    v_and_b32 v27, 0xffff0000, v9
    v_lshlrev_b32 v28, 16, v10
    v_and_b32 v29, 0xffff0000, v10
    v_lshlrev_b32 v30, 16, v11
    v_and_b32 v31, 0xffff0000, v11
    v_lshlrev_b32 v32, 16, v12
    v_and_b32 v33, 0xffff0000, v12
    v_lshlrev_b32 v34, 16, v13
    v_and_b32 v35, 0xffff0000, v13
    v_lshlrev_b32 v36, 16, v14
    v_and_b32 v37, 0xffff0000, v14
    v_lshlrev_b32 v38, 16, v15
    v_and_b32 v39, 0xffff0000, v15
    v_lshlrev_b32 v40, 16, v16
    v_and_b32 v41, 0xffff0000, v16
    v_lshlrev_b32 v42, 16, v17
    v_and_b32 v43, 0xffff0000, v17
    v_lshlrev_b32 v44, 16, v18
    v_and_b32 v45, 0xffff0000, v18
    v_lshlrev_b32 v46, 16, v19
    v_and_b32 v47, 0xffff0000, v19
    v_lshlrev_b32 v48, 16, v20
    v_and_b32 v49, 0xffff0000, v20
    v_lshlrev_b32 v50, 16, v21
    v_and_b32 v51, 0xffff0000, v21
    v_lshlrev_b32 v52, 16, v22
    v_and_b32 v53, 0xffff0000, v22
    v_lshlrev_b32 v54, 16, v23
    v_and_b32 v55, 0xffff0000, v23
    s_nop 1
    v_add_f32_dpp v57, v57, v57 quad_perm:[1,0,3,2] row_mask:0xf bank_mask:0xf
    s_nop 1
    v_add_f32_dpp v57, v57, v57 quad_perm:[2,3,0,1] row_mask:0xf bank_mask:0xf
    s_nop 1
    v_add_f32_dpp v57, v57, v57 row_half_mirror row_mask:0xf bank_mask:0xf
    s_nop 1
    v_add_f32_dpp v57, v57, v57 row_mirror row_mask:0xf bank_mask:0xf
    v_mul_f32 v57, 0x3b000000, v57
    v_cvt_pk_bf16_f32 v58, v57, v57
    v_lshlrev_b32 v58, 16, v58
    v_sub_f32 v66, 0, v58
    v_sub_f32 v57, v57, v58
    v_mov_b32 v68, 0
    v_mov_b32 v69, 0
    v_pk_add_f32 v[24:25], v[24:25], v[66:67] op_sel_hi:[1,0]
    v_pk_add_f32 v[26:27], v[26:27], v[66:67] op_sel_hi:[1,0]
    v_pk_add_f32 v[28:29], v[28:29], v[66:67] op_sel_hi:[1,0]
    v_pk_add_f32 v[30:31], v[30:31], v[66:67] op_sel_hi:[1,0]
    v_pk_add_f32 v[32:33], v[32:33], v[66:67] op_sel_hi:[1,0]
    v_pk_add_f32 v[34:35], v[34:35], v[66:67] op_sel_hi:[1,0]
    v_pk_add_f32 v[36:37], v[36:37], v[66:67] op_sel_hi:[1,0]
    v_pk_add_f32 v[38:39], v[38:39], v[66:67] op_sel_hi:[1,0]
    v_pk_add_f32 v[40:41], v[40:41], v[66:67] op_sel_hi:[1,0]
    v_pk_add_f32 v[42:43], v[42:43], v[66:67] op_sel_hi:[1,0]
    v_pk_add_f32 v[44:45], v[44:45], v[66:67] op_sel_hi:[1,0]
    v_pk_add_f32 v[46:47], v[46:47], v[66:67] op_sel_hi:[1,0]
    v_pk_add_f32 v[48:49], v[48:49], v[66:67] op_sel_hi:[1,0]
    v_pk_add_f32 v[50:51], v[50:51], v[66:67] op_sel_hi:[1,0]
    v_pk_add_f32 v[52:53], v[52:53], v[66:67] op_sel_hi:[1,0]
    v_pk_add_f32 v[54:55], v[54:55], v[66:67] op_sel_hi:[1,0]
    v_pk_fma_f32 v[68:69], v[24:25], v[24:25], v[68:69]
    v_pk_fma_f32 v[68:69], v[26:27], v[26:27], v[68:69]
    v_pk_fma_f32 v[68:69], v[28:29], v[28:29], v[68:69]
    v_pk_fma_f32 v[68:69], v[30:31], v[30:31], v[68:69]
    v_pk_fma_f32 v[68:69], v[32:33], v[32:33], v[68:69]
    v_pk_fma_f32 v[68:69], v[34:35], v[34:35], v[68:69]
    v_pk_fma_f32 v[68:69], v[36:37], v[36:37], v[68:69]
    v_pk_fma_f32 v[68:69], v[38:39], v[38:39], v[68:69]
    v_pk_fma_f32 v[68:69], v[40:41], v[40:41], v[68:69]
    v_pk_fma_f32 v[68:69], v[42:43], v[42:43], v[68:69]
    v_pk_fma_f32 v[68:69], v[44:45], v[44:45], v[68:69]
    v_pk_fma_f32 v[68:69], v[46:47], v[46:47], v[68:69]
    v_pk_fma_f32 v[68:69], v[48:49], v[48:49], v[68:69]
    v_pk_fma_f32 v[68:69], v[50:51], v[50:51], v[68:69]
    v_pk_fma_f32 v[68:69], v[52:53], v[52:53], v[68:69]
    v_pk_fma_f32 v[68:69], v[54:55], v[54:55], v[68:69]
    v_add_f32 v68, v68, v69
    s_nop 1
    v_add_f32_dpp v68, v68, v68 quad_perm:[1,0,3,2] row_mask:0xf bank_mask:0xf
    s_nop 1
    v_add_f32_dpp v68, v68, v68 quad_perm:[2,3,0,1] row_mask:0xf bank_mask:0xf
    s_nop 1
    v_add_f32_dpp v68, v68, v68 row_half_mirror row_mask:0xf bank_mask:0xf
    s_nop 1
    v_add_f32_dpp v68, v68, v68 row_mirror row_mask:0xf bank_mask:0xf
    v_mul_f32 v68, 0x3b000000, v68
    v_fma_f32 v68, -v57, v57, v68
    v_max_f32 v68, 0, v68
    v_cvt_pk_bf16_f32 v68, v68, v68
    v_lshlrev_b32 v68, 16, v68
    v_add_f32 v68, 0x3727c5ac, v68
    v_cvt_pk_bf16_f32 v68, v68, v68
    v_lshlrev_b32 v68, 16, v68
    v_sqrt_f32 v68, v68
    s_nop 0
    v_cvt_pk_bf16_f32 v68, v68, v68
    v_lshlrev_b32 v68, 16, v68
    v_rcp_f32 v66, v68
    v_cvt_pk_bf16_f32 v8, v24, v25
    v_cvt_pk_bf16_f32 v9, v26, v27
    v_cvt_pk_bf16_f32 v10, v28, v29
    v_cvt_pk_bf16_f32 v11, v30, v31
    v_cvt_pk_bf16_f32 v12, v32, v33
    v_cvt_pk_bf16_f32 v13, v34, v35
    v_cvt_pk_bf16_f32 v14, v36, v37
    v_cvt_pk_bf16_f32 v15, v38, v39
    v_cvt_pk_bf16_f32 v16, v40, v41
    v_cvt_pk_bf16_f32 v17, v42, v43
    v_cvt_pk_bf16_f32 v18, v44, v45
    v_cvt_pk_bf16_f32 v19, v46, v47
    v_cvt_pk_bf16_f32 v20, v48, v49
    v_cvt_pk_bf16_f32 v21, v50, v51
    v_cvt_pk_bf16_f32 v22, v52, v53
    v_cvt_pk_bf16_f32 v23, v54, v55
    v_lshlrev_b32 v24, 16, v8
    v_and_b32 v25, 0xffff0000, v8
    v_lshlrev_b32 v26, 16, v9
    v_and_b32 v27, 0xffff0000, v9
    v_lshlrev_b32 v28, 16, v10
    v_and_b32 v29, 0xffff0000, v10
    v_lshlrev_b32 v30, 16, v11
    v_and_b32 v31, 0xffff0000, v11
    v_lshlrev_b32 v32, 16, v12
    v_and_b32 v33, 0xffff0000, v12
    v_lshlrev_b32 v34, 16, v13
    v_and_b32 v35, 0xffff0000, v13
    v_lshlrev_b32 v36, 16, v14
    v_and_b32 v37, 0xffff0000, v14
    v_lshlrev_b32 v38, 16, v15
    v_and_b32 v39, 0xffff0000, v15
    v_lshlrev_b32 v40, 16, v16
    v_and_b32 v41, 0xffff0000, v16
    v_lshlrev_b32 v42, 16, v17
    v_and_b32 v43, 0xffff0000, v17
    v_lshlrev_b32 v44, 16, v18
    v_and_b32 v45, 0xffff0000, v18
    v_lshlrev_b32 v46, 16, v19
    v_and_b32 v47, 0xffff0000, v19
    v_lshlrev_b32 v48, 16, v20
    v_and_b32 v49, 0xffff0000, v20
    v_lshlrev_b32 v50, 16, v21
    v_and_b32 v51, 0xffff0000, v21
    v_lshlrev_b32 v52, 16, v22
    v_and_b32 v53, 0xffff0000, v22
    v_lshlrev_b32 v54, 16, v23
    v_and_b32 v55, 0xffff0000, v23
    v_pk_mul_f32 v[24:25], v[24:25], v[66:67] op_sel_hi:[1,0]
    v_pk_mul_f32 v[26:27], v[26:27], v[66:67] op_sel_hi:[1,0]
    v_pk_mul_f32 v[28:29], v[28:29], v[66:67] op_sel_hi:[1,0]
    v_pk_mul_f32 v[30:31], v[30:31], v[66:67] op_sel_hi:[1,0]
    v_pk_mul_f32 v[32:33], v[32:33], v[66:67] op_sel_hi:[1,0]
    v_pk_mul_f32 v[34:35], v[34:35], v[66:67] op_sel_hi:[1,0]
    v_pk_mul_f32 v[36:37], v[36:37], v[66:67] op_sel_hi:[1,0]
    v_pk_mul_f32 v[38:39], v[38:39], v[66:67] op_sel_hi:[1,0]
    v_pk_mul_f32 v[40:41], v[40:41], v[66:67] op_sel_hi:[1,0]
    v_pk_mul_f32 v[42:43], v[42:43], v[66:67] op_sel_hi:[1,0]
    v_pk_mul_f32 v[44:45], v[44:45], v[66:67] op_sel_hi:[1,0]
    v_pk_mul_f32 v[46:47], v[46:47], v[66:67] op_sel_hi:[1,0]
    v_pk_mul_f32 v[48:49], v[48:49], v[66:67] op_sel_hi:[1,0]
    v_pk_mul_f32 v[50:51], v[50:51], v[66:67] op_sel_hi:[1,0]
    v_pk_mul_f32 v[52:53], v[52:53], v[66:67] op_sel_hi:[1,0]
    v_pk_mul_f32 v[54:55], v[54:55], v[66:67] op_sel_hi:[1,0]
    v_cvt_pk_bf16_f32 v8, v24, v25
    v_cvt_pk_bf16_f32 v9, v26, v27
    v_cvt_pk_bf16_f32 v10, v28, v29
    v_cvt_pk_bf16_f32 v11, v30, v31
    v_cvt_pk_bf16_f32 v12, v32, v33
    v_cvt_pk_bf16_f32 v13, v34, v35
    v_cvt_pk_bf16_f32 v14, v36, v37
    v_cvt_pk_bf16_f32 v15, v38, v39
    v_cvt_pk_bf16_f32 v16, v40, v41
    v_cvt_pk_bf16_f32 v17, v42, v43
    v_cvt_pk_bf16_f32 v18, v44, v45
    v_cvt_pk_bf16_f32 v19, v46, v47
    v_cvt_pk_bf16_f32 v20, v48, v49
    v_cvt_pk_bf16_f32 v21, v50, v51
    v_cvt_pk_bf16_f32 v22, v52, v53
    v_cvt_pk_bf16_f32 v23, v54, v55
    ds_write_b128 v60, v[8:11] offset:0
    ds_write_b128 v60, v[12:15] offset:8192
    ds_write_b128 v60, v[16:19] offset:16384
    ds_write_b128 v60, v[20:23] offset:24576
    s_waitcnt vmcnt(0) lgkmcnt(0)
    s_barrier
    ds_read_b128 v[8:11], v61 offset:0
    ds_read_b128 v[12:15], v62 offset:1024
    ds_read_b128 v[16:19], v63 offset:2048
    ds_read_b128 v[20:23], v64 offset:3072
    s_cmp_lg_u32 s36, 2
    s_cbranch_scc1 m_kvp
    s_add_u32 s16, s12, 0
    s_addc_u32 s17, s13, 0
    s_and_b32 s17, s17, 0xffff
    s_mov_b32 s18, 2097152
    s_mov_b32 s19, 0x00020000
    s_lshl_b32 s41, s37, 15
    s_lshl_b32 s42, s3, 12
    s_add_u32 s41, s41, s42
    s_waitcnt lgkmcnt(0)
    buffer_store_dwordx4 v[8:11], v6, s[16:19], s41 offen offset:0 sc1
    buffer_store_dwordx4 v[12:15], v6, s[16:19], s41 offen offset:1024 sc1
    buffer_store_dwordx4 v[16:19], v6, s[16:19], s41 offen offset:2048 sc1
    buffer_store_dwordx4 v[20:23], v6, s[16:19], s41 offen offset:3072 sc1
    s_branch m_xsig
m_kvp:
    ds_read_b64_tr_b16 v[24:25], v65 offset:0
    ds_read_b64_tr_b16 v[26:27], v65 offset:128
    ds_read_b64_tr_b16 v[28:29], v65 offset:512
    ds_read_b64_tr_b16 v[30:31], v65 offset:640
    ds_read_b64_tr_b16 v[32:33], v65 offset:1024
    ds_read_b64_tr_b16 v[34:35], v65 offset:1152
    ds_read_b64_tr_b16 v[36:37], v65 offset:1536
    ds_read_b64_tr_b16 v[38:39], v65 offset:1664
    s_add_u32 s24, s12, 2097152
    s_addc_u32 s25, s13, 0
    s_and_b32 s25, s25, 0xffff
    s_mov_b32 s26, 131328
    s_mov_b32 s27, 0x00020000
    s_lshl_b32 s41, s3, 11
    s_add_u32 s41, s41, 49152
    v_add_u32 v4, s41, v6
    v_lshlrev_b32 v5, 4, v2
    v_lshl_add_u32 v5, v3, 8, v5
    v_add_u32 v7, s41, v5
    v_cmp_gt_u32 vcc, 16, v2
    s_mov_b64 s[50:51], vcc
    s_cmp_eq_u32 s36, 1
    s_cbranch_scc1 m_xv
    s_waitcnt lgkmcnt(6)
    v_mfma_f32_32x32x16_bf16 v[40:55], v[24:27], v[8:11], 0
    s_waitcnt lgkmcnt(4)
    v_mfma_f32_32x32x16_bf16 v[40:55], v[28:31], v[12:15], v[40:55]
    s_waitcnt lgkmcnt(2)
    v_mfma_f32_32x32x16_bf16 v[40:55], v[32:35], v[16:19], v[40:55]
    s_waitcnt lgkmcnt(0)
    v_mfma_f32_32x32x16_bf16 v[40:55], v[36:39], v[20:23], v[40:55]
    s_nop 15
    ds_write_b128 v4, v[40:43]
    ds_write_b128 v4, v[44:47] offset:1024
    s_waitcnt lgkmcnt(0)
    s_barrier
    s_cmp_lg_u32 s3, 0
    s_cbranch_scc1 m_xsig
    ds_read_b128 v[8:11], v4 offset:0
    ds_read_b128 v[12:15], v4 offset:1024
    ds_read_b128 v[16:19], v4 offset:2048
    ds_read_b128 v[20:23], v4 offset:3072
    ds_read_b128 v[24:27], v4 offset:4096
    ds_read_b128 v[28:31], v4 offset:5120
    ds_read_b128 v[32:35], v4 offset:6144
    ds_read_b128 v[36:39], v4 offset:7168
    ds_read_b128 v[40:43], v4 offset:8192
    ds_read_b128 v[44:47], v4 offset:9216
    ds_read_b128 v[48:51], v4 offset:10240
    ds_read_b128 v[52:55], v4 offset:11264
    ds_read_b128 v[56:59], v4 offset:12288
    ds_read_b128 v[60:63], v4 offset:13312
    ds_read_b128 v[64:67], v4 offset:14336
    ds_read_b128 v[68:71], v4 offset:15360
    s_waitcnt lgkmcnt(0)
    v_pk_add_f32 v[8:9], v[8:9], v[16:17]
    v_pk_add_f32 v[24:25], v[24:25], v[32:33]
    v_pk_add_f32 v[40:41], v[40:41], v[48:49]
    v_pk_add_f32 v[56:57], v[56:57], v[64:65]
    v_pk_add_f32 v[10:11], v[10:11], v[18:19]
    v_pk_add_f32 v[26:27], v[26:27], v[34:35]
    v_pk_add_f32 v[42:43], v[42:43], v[50:51]
    v_pk_add_f32 v[58:59], v[58:59], v[66:67]
    v_pk_add_f32 v[12:13], v[12:13], v[20:21]
    v_pk_add_f32 v[28:29], v[28:29], v[36:37]
    v_pk_add_f32 v[44:45], v[44:45], v[52:53]
    v_pk_add_f32 v[60:61], v[60:61], v[68:69]
    v_pk_add_f32 v[14:15], v[14:15], v[22:23]
    v_pk_add_f32 v[30:31], v[30:31], v[38:39]
    v_pk_add_f32 v[46:47], v[46:47], v[54:55]
    v_pk_add_f32 v[62:63], v[62:63], v[70:71]
    v_pk_add_f32 v[8:9], v[8:9], v[24:25]
    v_pk_add_f32 v[40:41], v[40:41], v[56:57]
    v_pk_add_f32 v[10:11], v[10:11], v[26:27]
    v_pk_add_f32 v[42:43], v[42:43], v[58:59]
    v_pk_add_f32 v[12:13], v[12:13], v[28:29]
    v_pk_add_f32 v[44:45], v[44:45], v[60:61]
    v_pk_add_f32 v[14:15], v[14:15], v[30:31]
    v_pk_add_f32 v[46:47], v[46:47], v[62:63]
    v_pk_add_f32 v[8:9], v[8:9], v[40:41]
    v_pk_add_f32 v[10:11], v[10:11], v[42:43]
    v_pk_add_f32 v[12:13], v[12:13], v[44:45]
    v_pk_add_f32 v[14:15], v[14:15], v[46:47]
    v_cvt_pk_bf16_f32 v16, v8, v9
    v_cvt_pk_bf16_f32 v17, v10, v11
    v_cvt_pk_bf16_f32 v18, v12, v13
    v_cvt_pk_bf16_f32 v19, v14, v15
    s_lshl_b32 s42, s37, 11
    buffer_store_dwordx4 v[16:19], v6, s[24:27], s42 offen sc1
    v_mul_f32 v20, v8, v8
    v_fmac_f32 v20, v9, v9
    v_fmac_f32 v20, v10, v10
    v_fmac_f32 v20, v11, v11
    v_fmac_f32 v20, v12, v12
    v_fmac_f32 v20, v13, v13
    v_fmac_f32 v20, v14, v14
    v_fmac_f32 v20, v15, v15
    v_mov_b32 v21, v20
    s_nop 1
    v_permlane32_swap_b32 v20, v21
    v_add_f32 v20, v20, v21
    s_nop 1
    v_max_f32_dpp v20, v20, v20 row_shr:1 row_mask:0xf bank_mask:0xf
    s_nop 1
    v_max_f32_dpp v20, v20, v20 row_shr:2 row_mask:0xf bank_mask:0xf
    s_nop 1
    v_max_f32_dpp v20, v20, v20 row_shr:4 row_mask:0xf bank_mask:0xf
    s_nop 1
    v_max_f32_dpp v20, v20, v20 row_shr:8 row_mask:0xf bank_mask:0xf
    s_nop 1
    v_readlane_b32 s44, v20, 15
    v_readlane_b32 s45, v20, 31
    v_readlane_b32 s46, v20, 47
    v_readlane_b32 s47, v20, 63
    s_nop 1
    v_mov_b32 v20, s44
    v_max_f32 v20, s45, v20
    v_max_f32 v20, s46, v20
    v_max_f32 v20, s47, v20
    s_nop 0
    v_readfirstlane_b32 s43, v20
    s_lshl_b32 s44, s37, 2
    s_add_u32 s44, s44, 131072
    v_mov_b32 v21, s43
    v_mov_b32 v22, 0
    s_mov_b64 exec, 1
    buffer_store_dword v21, v22, s[24:27], s44 offen sc1
    s_mov_b64 exec, -1
    s_branch m_xsig
m_xv:
    s_waitcnt lgkmcnt(6)
    v_mfma_f32_32x32x16_bf16 v[40:55], v[8:11], v[24:27], 0
    s_waitcnt lgkmcnt(4)
    v_mfma_f32_32x32x16_bf16 v[40:55], v[12:15], v[28:31], v[40:55]
    s_waitcnt lgkmcnt(2)
    v_mfma_f32_32x32x16_bf16 v[40:55], v[16:19], v[32:35], v[40:55]
    s_waitcnt lgkmcnt(0)
    v_mfma_f32_32x32x16_bf16 v[40:55], v[20:23], v[36:39], v[40:55]
    s_nop 7
    s_nop 7
    s_mov_b64 exec, s[50:51]
    ds_write_b128 v7, v[40:43] offset:0
    ds_write_b128 v7, v[44:47] offset:512
    ds_write_b128 v7, v[48:51] offset:1024
    ds_write_b128 v7, v[52:55] offset:1536
    s_mov_b64 exec, -1
    s_waitcnt lgkmcnt(0)
    s_barrier
    s_cmp_gt_u32 s3, 1
    s_cbranch_scc1 m_xsig
    s_lshl_b32 s41, s3, 10
    s_add_u32 s41, s41, 49152
    v_add_u32 v7, s41, v5
    s_mov_b64 exec, s[50:51]
    ds_read_b128 v[8:11], v7 offset:0
    ds_read_b128 v[12:15], v7 offset:512
    ds_read_b128 v[16:19], v7 offset:2048
    ds_read_b128 v[20:23], v7 offset:2560
    ds_read_b128 v[24:27], v7 offset:4096
    ds_read_b128 v[28:31], v7 offset:4608
    ds_read_b128 v[32:35], v7 offset:6144
    ds_read_b128 v[36:39], v7 offset:6656
    ds_read_b128 v[40:43], v7 offset:8192
    ds_read_b128 v[44:47], v7 offset:8704
    ds_read_b128 v[48:51], v7 offset:10240
    ds_read_b128 v[52:55], v7 offset:10752
    ds_read_b128 v[56:59], v7 offset:12288
    ds_read_b128 v[60:63], v7 offset:12800
    ds_read_b128 v[64:67], v7 offset:14336
    ds_read_b128 v[68:71], v7 offset:14848
    s_waitcnt lgkmcnt(0)
    v_pk_add_f32 v[8:9], v[8:9], v[16:17]
    v_pk_add_f32 v[24:25], v[24:25], v[32:33]
    v_pk_add_f32 v[40:41], v[40:41], v[48:49]
    v_pk_add_f32 v[56:57], v[56:57], v[64:65]
    v_pk_add_f32 v[10:11], v[10:11], v[18:19]
    v_pk_add_f32 v[26:27], v[26:27], v[34:35]
    v_pk_add_f32 v[42:43], v[42:43], v[50:51]
    v_pk_add_f32 v[58:59], v[58:59], v[66:67]
    v_pk_add_f32 v[12:13], v[12:13], v[20:21]
    v_pk_add_f32 v[28:29], v[28:29], v[36:37]
    v_pk_add_f32 v[44:45], v[44:45], v[52:53]
    v_pk_add_f32 v[60:61], v[60:61], v[68:69]
    v_pk_add_f32 v[14:15], v[14:15], v[22:23]
    v_pk_add_f32 v[30:31], v[30:31], v[38:39]
    v_pk_add_f32 v[46:47], v[46:47], v[54:55]
    v_pk_add_f32 v[62:63], v[62:63], v[70:71]
    v_pk_add_f32 v[8:9], v[8:9], v[24:25]
    v_pk_add_f32 v[40:41], v[40:41], v[56:57]
    v_pk_add_f32 v[10:11], v[10:11], v[26:27]
    v_pk_add_f32 v[42:43], v[42:43], v[58:59]
    v_pk_add_f32 v[12:13], v[12:13], v[28:29]
    v_pk_add_f32 v[44:45], v[44:45], v[60:61]
    v_pk_add_f32 v[14:15], v[14:15], v[30:31]
    v_pk_add_f32 v[46:47], v[46:47], v[62:63]
    v_pk_add_f32 v[8:9], v[8:9], v[40:41]
    v_pk_add_f32 v[10:11], v[10:11], v[42:43]
    v_pk_add_f32 v[12:13], v[12:13], v[44:45]
    v_pk_add_f32 v[14:15], v[14:15], v[46:47]
    v_cvt_pk_bf16_f32 v16, v8, v9
    v_cvt_pk_bf16_f32 v17, v10, v11
    v_cvt_pk_bf16_f32 v18, v12, v13
    v_cvt_pk_bf16_f32 v19, v14, v15
    s_lshl_b32 s41, s37, 11
    s_lshl_b32 s42, s3, 9
    s_add_u32 s41, s41, s42
    s_add_u32 s41, s41, 1024
    buffer_store_dwordx4 v[16:19], v5, s[24:27], s41 offen sc1
    s_mov_b64 exec, -1
m_xsig:
    s_waitcnt vmcnt(0)
    s_barrier
    s_cmp_lg_u32 s3, 0
    s_cbranch_scc1 xsig_2
    v_readfirstlane_b32 s68, v124
    v_readfirstlane_b32 s69, v125
    s_or_b32 s46, s68, s69
    s_cmp_lg_u32 s46, 0
    s_cbranch_scc1 m_eok_3
    v_mov_b32 v126, 0
m_ep_4:
    global_load_dwordx2 v[124:125], v126, s[14:15] sc1
    s_waitcnt vmcnt(0)
    v_readfirstlane_b32 s68, v124
    v_readfirstlane_b32 s69, v125
    s_or_b32 s46, s68, s69
    s_cmp_eq_u32 s46, 0
    s_cbranch_scc1 m_ep_4
m_eok_3:
    s_lshl_b32 s41, s37, 4
    s_lshl_b32 s42, s36, 3
    s_add_u32 s41, s41, s42
    s_add_u32 s41, s41, 3162112
    s_lshr_b32 s42, s37, 2
    s_lshl_b32 s42, s42, 7
    s_and_b32 s43, s37, 3
    s_lshl_b32 s43, s43, 3
    s_add_u32 s42, s42, s43
    s_add_u32 s42, s42, 3146752
    s_cmp_eq_u32 s36, 2
    s_cselect_b32 s41, s42, s41
    s_cselect_b32 s42, 1, 0xff
    v_lshlrev_b32 v5, 10, v1
    v_add_u32 v5, s41, v5
    v_mov_b32 v124, s68
    v_mov_b32 v125, s69
    s_mov_b32 exec_lo, s42
    s_mov_b32 exec_hi, 0
    global_store_dwordx2 v5, v[124:125], s[12:13] sc1
    s_mov_b64 exec, -1
xsig_2:
    s_branch m_gmain2
m_gsleep:
    s_cmp_lg_u32 s3, 0
    s_cbranch_scc1 m_gsl2
    v_mov_b32 v126, 0
m_ep_5:
    global_load_dwordx2 v[124:125], v126, s[14:15] sc1
    s_waitcnt vmcnt(0)
    v_readfirstlane_b32 s68, v124
    v_readfirstlane_b32 s69, v125
    s_or_b32 s46, s68, s69
    s_cmp_eq_u32 s46, 0
    s_cbranch_scc1 m_ep_5
m_gsl2:
    s_barrier
m_gmain2:
    s_setprio 0
    s_sub_u32 s2, s2, 256
    s_load_dwordx4 s[4:7], s[0:1], 48
    s_load_dwordx4 s[8:11], s[0:1], 64
    s_load_dwordx2 s[56:57], s[0:1], 0
    s_load_dwordx2 s[58:59], s[0:1], 32
    v_lshlrev_b32 v126, 7, v1
    s_and_b32 s61, s2, 31
    s_lshr_b32 s60, s2, 5
    s_waitcnt lgkmcnt(0)
    s_add_u32 s28, s12, 6291456
    s_addc_u32 s29, s13, 0
    s_and_b32 s29, s29, 0xffff
    s_mov_b32 s30, 9437184
    s_mov_b32 s31, 0x00020000
    s_mov_b32 s64, s8
    s_and_b32 s65, s9, 0xffff
    s_mov_b32 s66, 1835008
    s_mov_b32 s67, 0x00020000
    s_mov_b32 s32, s58
    s_and_b32 s33, s59, 0xffff
    s_mov_b32 s34, 524288
    s_mov_b32 s35, 0x00020000
    s_cmp_ge_u32 s2, 224
    s_cbranch_scc1 m_down
    s_mov_b32 s53, s2
    s_and_b32 s36, s53, 7
    s_lshr_b32 s37, s53, 3
    s_and_b32 s38, s36, 3
    s_lshl_b32 s38, s38, 2
    s_and_b32 s39, s37, 3
    s_add_u32 s38, s38, s39
    s_lshr_b32 s39, s36, 2
    s_mul_i32 s39, s39, 7
    s_lshr_b32 s37, s37, 2
    s_add_u32 s39, s39, s37
    s_and_b32 s36, s3, 1
    s_lshr_b32 s37, s3, 1
    s_mov_b32 s16, s4
    s_and_b32 s17, s5, 0xffff
    s_mov_b32 s18, 1835008
    s_mov_b32 s19, 0x00020000
    s_mov_b32 s20, s6
    s_and_b32 s21, s7, 0xffff
    s_mov_b32 s22, 1835008
    s_mov_b32 s23, 0x00020000
    s_add_u32 s24, s12, 0
    s_addc_u32 s25, s13, 0
    s_and_b32 s25, s25, 0xffff
    s_mov_b32 s26, 2097152
    s_mov_b32 s27, 0x00020000
    v_lshrrev_b32 v7, 4, v1
    v_bfe_u32 v8, v1, 2, 2
    v_xor_b32 v8, v8, v7
    s_mov_b32 s40, 3584
    v_mul_lo_u32 v7, v7, s40
    v_lshl_add_u32 v7, v8, 6, v7
    v_and_b32 v8, 3, v1
    v_lshl_add_u32 v7, v8, 4, v7
    s_lshl_b32 s41, s38, 2
    s_add_u32 s41, s41, s37
    s_lshl_b32 s41, s41, 15
    s_lshl_b32 s42, s36, 10
    s_add_u32 s41, s41, s42
    s_mul_i32 s42, s3, 14336
    s_lshl_b32 s43, s39, 8
    s_add_u32 s42, s42, s43
    s_lshl_b32 s44, s3, 10
    s_add_u32 m0, s44, 8192
    s_nop 0
    buffer_load_dwordx4 v7, s[16:19], s42 offen lds
    s_add_u32 m0, s44, 16384
    s_nop 0
    buffer_load_dwordx4 v7, s[20:23], s42 offen lds
    s_add_u32 s42, s42, 114688
    s_add_u32 m0, s44, 32768
    s_nop 0
    buffer_load_dwordx4 v7, s[16:19], s42 offen lds
    s_add_u32 m0, s44, 40960
    s_nop 0
    buffer_load_dwordx4 v7, s[20:23], s42 offen lds
    s_add_u32 s42, s42, 114688
    s_add_u32 m0, s44, 57344
    s_nop 0
    buffer_load_dwordx4 v7, s[16:19], s42 offen lds
    s_add_u32 m0, s44, 65536
    s_nop 0
    buffer_load_dwordx4 v7, s[20:23], s42 offen lds
    s_add_u32 s42, s42, 114688
    v_bfe_u32 v8, v1, 2, 2
    v_lshl_add_u32 v9, v3, 3, v8
    v_lshlrev_b32 v9, 8, v9
    v_bfe_u32 v10, v1, 4, 1
    v_lshl_add_u32 v9, v10, 5, v9
    v_and_b32 v10, 3, v1
    v_lshl_add_u32 v9, v10, 3, v9
    v_add_u32 v9, 8192, v9
    v_xor_b32 v10, s37, v8
    v_lshl_add_u32 v10, v10, 6, v9
    s_lshl_b32 s46, s36, 12
    v_add_u32 v12, s46, v6
    s_lshl_b32 s49, s38, 7
    s_add_u32 s49, s49, 3146752
    s_cmp_lg_u32 s3, 0
    s_cbranch_scc1 m_polled_7
    v_mov_b32 v126, 0
m_ep_8:
    global_load_dwordx2 v[124:125], v126, s[14:15] sc1
    s_waitcnt vmcnt(0)
    v_readfirstlane_b32 s68, v124
    v_readfirstlane_b32 s69, v125
    s_or_b32 s46, s68, s69
    s_cmp_eq_u32 s46, 0
    s_cbranch_scc1 m_ep_8
    v_lshlrev_b32 v4, 3, v1
    v_add_u32 v4, s49, v4
    s_mov_b64 s[46:47], exec
    s_mov_b32 exec_lo, 0xf
    s_mov_b32 exec_hi, 0x0
m_poll_6:
    global_load_dwordx2 v[124:125], v4, s[12:13] sc1
    s_waitcnt vmcnt(0)
    v_cmp_ne_u64 vcc, s[68:69], v[124:125]
    s_cmp_eq_u64 vcc, 0
    s_cbranch_scc1 m_poll_6_ok
    s_sleep 2
    s_branch m_poll_6
m_poll_6_ok:
    s_mov_b64 exec, s[46:47]
m_polled_7:
    s_barrier
    s_add_u32 m0, s44, 0
    s_nop 0
    buffer_load_dwordx4 v6, s[24:27], s41 offen lds
    s_add_u32 s41, s41, 2048
    s_add_u32 m0, s44, 24576
    s_nop 0
    buffer_load_dwordx4 v6, s[24:27], s41 offen lds
    s_add_u32 s41, s41, 2048
    s_add_u32 m0, s44, 49152
    s_nop 0
    buffer_load_dwordx4 v6, s[24:27], s41 offen lds
    s_add_u32 s41, s41, 2048
    s_waitcnt vmcnt(2)
    s_barrier
    ds_read_b128 v[96:99], v12 offset:0
    ds_read_b128 v[100:103], v12 offset:2048
    ds_read_b64_tr_b16 v[80:81], v10 offset:0
    ds_read_b64_tr_b16 v[82:83], v10 offset:1024
    ds_read_b64_tr_b16 v[84:85], v10 offset:8192
    ds_read_b64_tr_b16 v[86:87], v10 offset:9216
    s_waitcnt lgkmcnt(0)
    v_mfma_f32_32x32x16_bf16 v[16:31], v[80:83], v[96:99], 0
    ds_read_b128 v[104:107], v12 offset:1024
    ds_read_b128 v[108:111], v12 offset:3072
    v_mfma_f32_32x32x16_bf16 v[32:47], v[80:83], v[100:103], 0
    ds_read_b64_tr_b16 v[88:89], v10 offset:4096
    ds_read_b64_tr_b16 v[90:91], v10 offset:5120
    v_mfma_f32_32x32x16_bf16 v[48:63], v[84:87], v[96:99], 0
    ds_read_b64_tr_b16 v[92:93], v10 offset:12288
    v_mfma_f32_32x32x16_bf16 v[64:79], v[84:87], v[100:103], 0
    ds_read_b64_tr_b16 v[94:95], v10 offset:13312
    s_waitcnt vmcnt(1) lgkmcnt(0)
    s_barrier
    v_mfma_f32_32x32x16_bf16 v[16:31], v[88:91], v[104:107], v[16:31]
    ds_read_b128 v[96:99], v12 offset:24576
    ds_read_b128 v[100:103], v12 offset:26624
    s_add_u32 m0, s44, 0
    s_nop 0
    buffer_load_dwordx4 v6, s[24:27], s41 offen lds
    s_add_u32 s41, s41, 2048
    v_mfma_f32_32x32x16_bf16 v[32:47], v[88:91], v[108:111], v[32:47]
    ds_read_b64_tr_b16 v[80:81], v10 offset:24576
    ds_read_b64_tr_b16 v[82:83], v10 offset:25600
    s_add_u32 m0, s44, 8192
    s_nop 0
    buffer_load_dwordx4 v7, s[16:19], s42 offen lds
    v_mfma_f32_32x32x16_bf16 v[48:63], v[92:95], v[104:107], v[48:63]
    ds_read_b64_tr_b16 v[84:85], v10 offset:32768
    s_add_u32 m0, s44, 16384
    s_nop 0
    buffer_load_dwordx4 v7, s[20:23], s42 offen lds
    s_add_u32 s42, s42, 114688
    v_mfma_f32_32x32x16_bf16 v[64:79], v[92:95], v[108:111], v[64:79]
    ds_read_b64_tr_b16 v[86:87], v10 offset:33792
    s_waitcnt lgkmcnt(0)
    v_mfma_f32_32x32x16_bf16 v[16:31], v[80:83], v[96:99], v[16:31]
    ds_read_b128 v[104:107], v12 offset:25600
    ds_read_b128 v[108:111], v12 offset:27648
    v_mfma_f32_32x32x16_bf16 v[32:47], v[80:83], v[100:103], v[32:47]
    ds_read_b64_tr_b16 v[88:89], v10 offset:28672
    ds_read_b64_tr_b16 v[90:91], v10 offset:29696
    v_mfma_f32_32x32x16_bf16 v[48:63], v[84:87], v[96:99], v[48:63]
    ds_read_b64_tr_b16 v[92:93], v10 offset:36864
    v_mfma_f32_32x32x16_bf16 v[64:79], v[84:87], v[100:103], v[64:79]
    ds_read_b64_tr_b16 v[94:95], v10 offset:37888
    s_waitcnt vmcnt(3) lgkmcnt(0)
    s_barrier
    v_mfma_f32_32x32x16_bf16 v[16:31], v[88:91], v[104:107], v[16:31]
    ds_read_b128 v[96:99], v12 offset:49152
    ds_read_b128 v[100:103], v12 offset:51200
    s_add_u32 m0, s44, 24576
    s_nop 0
    buffer_load_dwordx4 v6, s[24:27], s41 offen lds
    s_add_u32 s41, s41, 2048
    v_mfma_f32_32x32x16_bf16 v[32:47], v[88:91], v[108:111], v[32:47]
    ds_read_b64_tr_b16 v[80:81], v10 offset:49152
    ds_read_b64_tr_b16 v[82:83], v10 offset:50176
    s_add_u32 m0, s44, 32768
    s_nop 0
    buffer_load_dwordx4 v7, s[16:19], s42 offen lds
    v_mfma_f32_32x32x16_bf16 v[48:63], v[92:95], v[104:107], v[48:63]
    ds_read_b64_tr_b16 v[84:85], v10 offset:57344
    s_add_u32 m0, s44, 40960
    s_nop 0
    buffer_load_dwordx4 v7, s[20:23], s42 offen lds
    s_add_u32 s42, s42, 114688
    v_mfma_f32_32x32x16_bf16 v[64:79], v[92:95], v[108:111], v[64:79]
    ds_read_b64_tr_b16 v[86:87], v10 offset:58368
    s_waitcnt lgkmcnt(0)
    v_mfma_f32_32x32x16_bf16 v[16:31], v[80:83], v[96:99], v[16:31]
    ds_read_b128 v[104:107], v12 offset:50176
    ds_read_b128 v[108:111], v12 offset:52224
    v_mfma_f32_32x32x16_bf16 v[32:47], v[80:83], v[100:103], v[32:47]
    ds_read_b64_tr_b16 v[88:89], v10 offset:53248
    ds_read_b64_tr_b16 v[90:91], v10 offset:54272
    v_mfma_f32_32x32x16_bf16 v[48:63], v[84:87], v[96:99], v[48:63]
    ds_read_b64_tr_b16 v[92:93], v10 offset:61440
    v_mfma_f32_32x32x16_bf16 v[64:79], v[84:87], v[100:103], v[64:79]
    ds_read_b64_tr_b16 v[94:95], v10 offset:62464
    s_waitcnt vmcnt(3) lgkmcnt(0)
    s_barrier
    v_mfma_f32_32x32x16_bf16 v[16:31], v[88:91], v[104:107], v[16:31]
    ds_read_b128 v[96:99], v12 offset:0
    ds_read_b128 v[100:103], v12 offset:2048
    s_add_u32 m0, s44, 49152
    s_nop 0
    buffer_load_dwordx4 v6, s[24:27], s41 offen lds
    s_add_u32 s41, s41, 2048
    v_mfma_f32_32x32x16_bf16 v[32:47], v[88:91], v[108:111], v[32:47]
    ds_read_b64_tr_b16 v[80:81], v10 offset:0
    ds_read_b64_tr_b16 v[82:83], v10 offset:1024
    s_add_u32 m0, s44, 57344
    s_nop 0
    buffer_load_dwordx4 v7, s[16:19], s42 offen lds
    v_mfma_f32_32x32x16_bf16 v[48:63], v[92:95], v[104:107], v[48:63]
    ds_read_b64_tr_b16 v[84:85], v10 offset:8192
    s_add_u32 m0, s44, 65536
    s_nop 0
    buffer_load_dwordx4 v7, s[20:23], s42 offen lds
    s_add_u32 s42, s42, 114688
    v_mfma_f32_32x32x16_bf16 v[64:79], v[92:95], v[108:111], v[64:79]
    ds_read_b64_tr_b16 v[86:87], v10 offset:9216
    s_waitcnt lgkmcnt(0)
    v_mfma_f32_32x32x16_bf16 v[16:31], v[80:83], v[96:99], v[16:31]
    ds_read_b128 v[104:107], v12 offset:1024
    ds_read_b128 v[108:111], v12 offset:3072
    v_mfma_f32_32x32x16_bf16 v[32:47], v[80:83], v[100:103], v[32:47]
    ds_read_b64_tr_b16 v[88:89], v10 offset:4096
    ds_read_b64_tr_b16 v[90:91], v10 offset:5120
    v_mfma_f32_32x32x16_bf16 v[48:63], v[84:87], v[96:99], v[48:63]
    ds_read_b64_tr_b16 v[92:93], v10 offset:12288
    v_mfma_f32_32x32x16_bf16 v[64:79], v[84:87], v[100:103], v[64:79]
    ds_read_b64_tr_b16 v[94:95], v10 offset:13312
    s_waitcnt vmcnt(3) lgkmcnt(0)
    s_barrier
    v_mfma_f32_32x32x16_bf16 v[16:31], v[88:91], v[104:107], v[16:31]
    ds_read_b128 v[96:99], v12 offset:24576
    ds_read_b128 v[100:103], v12 offset:26624
    s_add_u32 m0, s44, 0
    s_nop 0
    buffer_load_dwordx4 v6, s[24:27], s41 offen lds
    s_add_u32 s41, s41, 2048
    v_mfma_f32_32x32x16_bf16 v[32:47], v[88:91], v[108:111], v[32:47]
    ds_read_b64_tr_b16 v[80:81], v10 offset:24576
    ds_read_b64_tr_b16 v[82:83], v10 offset:25600
    s_add_u32 m0, s44, 8192
    s_nop 0
    buffer_load_dwordx4 v7, s[16:19], s42 offen lds
    v_mfma_f32_32x32x16_bf16 v[48:63], v[92:95], v[104:107], v[48:63]
    ds_read_b64_tr_b16 v[84:85], v10 offset:32768
    s_add_u32 m0, s44, 16384
    s_nop 0
    buffer_load_dwordx4 v7, s[20:23], s42 offen lds
    s_add_u32 s42, s42, 114688
    v_mfma_f32_32x32x16_bf16 v[64:79], v[92:95], v[108:111], v[64:79]
    ds_read_b64_tr_b16 v[86:87], v10 offset:33792
    s_waitcnt lgkmcnt(0)
    v_mfma_f32_32x32x16_bf16 v[16:31], v[80:83], v[96:99], v[16:31]
    ds_read_b128 v[104:107], v12 offset:25600
    ds_read_b128 v[108:111], v12 offset:27648
    v_mfma_f32_32x32x16_bf16 v[32:47], v[80:83], v[100:103], v[32:47]
    ds_read_b64_tr_b16 v[88:89], v10 offset:28672
    ds_read_b64_tr_b16 v[90:91], v10 offset:29696
    v_mfma_f32_32x32x16_bf16 v[48:63], v[84:87], v[96:99], v[48:63]
    ds_read_b64_tr_b16 v[92:93], v10 offset:36864
    v_mfma_f32_32x32x16_bf16 v[64:79], v[84:87], v[100:103], v[64:79]
    ds_read_b64_tr_b16 v[94:95], v10 offset:37888
    s_waitcnt vmcnt(3) lgkmcnt(0)
    s_barrier
    v_mfma_f32_32x32x16_bf16 v[16:31], v[88:91], v[104:107], v[16:31]
    ds_read_b128 v[96:99], v12 offset:49152
    ds_read_b128 v[100:103], v12 offset:51200
    s_add_u32 m0, s44, 24576
    s_nop 0
    buffer_load_dwordx4 v6, s[24:27], s41 offen lds
    s_add_u32 s41, s41, 2048
    v_mfma_f32_32x32x16_bf16 v[32:47], v[88:91], v[108:111], v[32:47]
    ds_read_b64_tr_b16 v[80:81], v10 offset:49152
    ds_read_b64_tr_b16 v[82:83], v10 offset:50176
    s_add_u32 m0, s44, 32768
    s_nop 0
    buffer_load_dwordx4 v7, s[16:19], s42 offen lds
    v_mfma_f32_32x32x16_bf16 v[48:63], v[92:95], v[104:107], v[48:63]
    ds_read_b64_tr_b16 v[84:85], v10 offset:57344
    s_add_u32 m0, s44, 40960
    s_nop 0
    buffer_load_dwordx4 v7, s[20:23], s42 offen lds
    s_add_u32 s42, s42, 114688
    v_mfma_f32_32x32x16_bf16 v[64:79], v[92:95], v[108:111], v[64:79]
    ds_read_b64_tr_b16 v[86:87], v10 offset:58368
    s_waitcnt lgkmcnt(0)
    v_mfma_f32_32x32x16_bf16 v[16:31], v[80:83], v[96:99], v[16:31]
    ds_read_b128 v[104:107], v12 offset:50176
    ds_read_b128 v[108:111], v12 offset:52224
    v_mfma_f32_32x32x16_bf16 v[32:47], v[80:83], v[100:103], v[32:47]
    ds_read_b64_tr_b16 v[88:89], v10 offset:53248
    ds_read_b64_tr_b16 v[90:91], v10 offset:54272
    v_mfma_f32_32x32x16_bf16 v[48:63], v[84:87], v[96:99], v[48:63]
    ds_read_b64_tr_b16 v[92:93], v10 offset:61440
    v_mfma_f32_32x32x16_bf16 v[64:79], v[84:87], v[100:103], v[64:79]
    ds_read_b64_tr_b16 v[94:95], v10 offset:62464
    s_waitcnt vmcnt(3) lgkmcnt(0)
    s_barrier
    v_mfma_f32_32x32x16_bf16 v[16:31], v[88:91], v[104:107], v[16:31]
    ds_read_b128 v[96:99], v12 offset:0
    ds_read_b128 v[100:103], v12 offset:2048
    s_add_u32 m0, s44, 49152
    s_nop 0
    buffer_load_dwordx4 v6, s[24:27], s41 offen lds
    s_add_u32 s41, s41, 2048
    v_mfma_f32_32x32x16_bf16 v[32:47], v[88:91], v[108:111], v[32:47]
    ds_read_b64_tr_b16 v[80:81], v10 offset:0
    ds_read_b64_tr_b16 v[82:83], v10 offset:1024
    s_add_u32 m0, s44, 57344
    s_nop 0
    buffer_load_dwordx4 v7, s[16:19], s42 offen lds
    v_mfma_f32_32x32x16_bf16 v[48:63], v[92:95], v[104:107], v[48:63]
    ds_read_b64_tr_b16 v[84:85], v10 offset:8192
    s_add_u32 m0, s44, 65536
    s_nop 0
    buffer_load_dwordx4 v7, s[20:23], s42 offen lds
    s_add_u32 s42, s42, 114688
    v_mfma_f32_32x32x16_bf16 v[64:79], v[92:95], v[108:111], v[64:79]
    ds_read_b64_tr_b16 v[86:87], v10 offset:9216
    s_waitcnt lgkmcnt(0)
    v_mfma_f32_32x32x16_bf16 v[16:31], v[80:83], v[96:99], v[16:31]
    ds_read_b128 v[104:107], v12 offset:1024
    ds_read_b128 v[108:111], v12 offset:3072
    v_mfma_f32_32x32x16_bf16 v[32:47], v[80:83], v[100:103], v[32:47]
    ds_read_b64_tr_b16 v[88:89], v10 offset:4096
    ds_read_b64_tr_b16 v[90:91], v10 offset:5120
    v_mfma_f32_32x32x16_bf16 v[48:63], v[84:87], v[96:99], v[48:63]
    ds_read_b64_tr_b16 v[92:93], v10 offset:12288
    v_mfma_f32_32x32x16_bf16 v[64:79], v[84:87], v[100:103], v[64:79]
    ds_read_b64_tr_b16 v[94:95], v10 offset:13312
    s_waitcnt vmcnt(3) lgkmcnt(0)
    s_barrier
    v_mfma_f32_32x32x16_bf16 v[16:31], v[88:91], v[104:107], v[16:31]
    ds_read_b128 v[96:99], v12 offset:24576
    ds_read_b128 v[100:103], v12 offset:26624
    s_add_u32 m0, s44, 0
    s_nop 0
    buffer_load_dwordx4 v6, s[24:27], s41 offen lds
    s_add_u32 s41, s41, 2048
    v_mfma_f32_32x32x16_bf16 v[32:47], v[88:91], v[108:111], v[32:47]
    ds_read_b64_tr_b16 v[80:81], v10 offset:24576
    ds_read_b64_tr_b16 v[82:83], v10 offset:25600
    s_add_u32 m0, s44, 8192
    s_nop 0
    buffer_load_dwordx4 v7, s[16:19], s42 offen lds
    v_mfma_f32_32x32x16_bf16 v[48:63], v[92:95], v[104:107], v[48:63]
    ds_read_b64_tr_b16 v[84:85], v10 offset:32768
    s_add_u32 m0, s44, 16384
    s_nop 0
    buffer_load_dwordx4 v7, s[20:23], s42 offen lds
    s_add_u32 s42, s42, 114688
    v_mfma_f32_32x32x16_bf16 v[64:79], v[92:95], v[108:111], v[64:79]
    ds_read_b64_tr_b16 v[86:87], v10 offset:33792
    s_waitcnt lgkmcnt(0)
    v_mfma_f32_32x32x16_bf16 v[16:31], v[80:83], v[96:99], v[16:31]
    ds_read_b128 v[104:107], v12 offset:25600
    ds_read_b128 v[108:111], v12 offset:27648
    v_mfma_f32_32x32x16_bf16 v[32:47], v[80:83], v[100:103], v[32:47]
    ds_read_b64_tr_b16 v[88:89], v10 offset:28672
    ds_read_b64_tr_b16 v[90:91], v10 offset:29696
    v_mfma_f32_32x32x16_bf16 v[48:63], v[84:87], v[96:99], v[48:63]
    ds_read_b64_tr_b16 v[92:93], v10 offset:36864
    v_mfma_f32_32x32x16_bf16 v[64:79], v[84:87], v[100:103], v[64:79]
    ds_read_b64_tr_b16 v[94:95], v10 offset:37888
    s_waitcnt vmcnt(3) lgkmcnt(0)
    s_barrier
    v_mfma_f32_32x32x16_bf16 v[16:31], v[88:91], v[104:107], v[16:31]
    ds_read_b128 v[96:99], v12 offset:49152
    ds_read_b128 v[100:103], v12 offset:51200
    s_add_u32 m0, s44, 24576
    s_nop 0
    buffer_load_dwordx4 v6, s[24:27], s41 offen lds
    s_add_u32 s41, s41, 2048
    v_mfma_f32_32x32x16_bf16 v[32:47], v[88:91], v[108:111], v[32:47]
    ds_read_b64_tr_b16 v[80:81], v10 offset:49152
    ds_read_b64_tr_b16 v[82:83], v10 offset:50176
    s_add_u32 m0, s44, 32768
    s_nop 0
    buffer_load_dwordx4 v7, s[16:19], s42 offen lds
    v_mfma_f32_32x32x16_bf16 v[48:63], v[92:95], v[104:107], v[48:63]
    ds_read_b64_tr_b16 v[84:85], v10 offset:57344
    s_add_u32 m0, s44, 40960
    s_nop 0
    buffer_load_dwordx4 v7, s[20:23], s42 offen lds
    s_add_u32 s42, s42, 114688
    v_mfma_f32_32x32x16_bf16 v[64:79], v[92:95], v[108:111], v[64:79]
    ds_read_b64_tr_b16 v[86:87], v10 offset:58368
    s_waitcnt lgkmcnt(0)
    v_mfma_f32_32x32x16_bf16 v[16:31], v[80:83], v[96:99], v[16:31]
    ds_read_b128 v[104:107], v12 offset:50176
    ds_read_b128 v[108:111], v12 offset:52224
    v_mfma_f32_32x32x16_bf16 v[32:47], v[80:83], v[100:103], v[32:47]
    ds_read_b64_tr_b16 v[88:89], v10 offset:53248
    ds_read_b64_tr_b16 v[90:91], v10 offset:54272
    v_mfma_f32_32x32x16_bf16 v[48:63], v[84:87], v[96:99], v[48:63]
    ds_read_b64_tr_b16 v[92:93], v10 offset:61440
    v_mfma_f32_32x32x16_bf16 v[64:79], v[84:87], v[100:103], v[64:79]
    ds_read_b64_tr_b16 v[94:95], v10 offset:62464
    s_waitcnt vmcnt(3) lgkmcnt(0)
    s_barrier
    v_mfma_f32_32x32x16_bf16 v[16:31], v[88:91], v[104:107], v[16:31]
    ds_read_b128 v[96:99], v12 offset:0
    ds_read_b128 v[100:103], v12 offset:2048
    s_add_u32 m0, s44, 49152
    s_nop 0
    buffer_load_dwordx4 v6, s[24:27], s41 offen lds
    s_add_u32 s41, s41, 2048
    v_mfma_f32_32x32x16_bf16 v[32:47], v[88:91], v[108:111], v[32:47]
    ds_read_b64_tr_b16 v[80:81], v10 offset:0
    ds_read_b64_tr_b16 v[82:83], v10 offset:1024
    s_add_u32 m0, s44, 57344
    s_nop 0
    buffer_load_dwordx4 v7, s[16:19], s42 offen lds
    v_mfma_f32_32x32x16_bf16 v[48:63], v[92:95], v[104:107], v[48:63]
    ds_read_b64_tr_b16 v[84:85], v10 offset:8192
    s_add_u32 m0, s44, 65536
    s_nop 0
    buffer_load_dwordx4 v7, s[20:23], s42 offen lds
    s_add_u32 s42, s42, 114688
    v_mfma_f32_32x32x16_bf16 v[64:79], v[92:95], v[108:111], v[64:79]
    ds_read_b64_tr_b16 v[86:87], v10 offset:9216
    s_waitcnt lgkmcnt(0)
    v_mfma_f32_32x32x16_bf16 v[16:31], v[80:83], v[96:99], v[16:31]
    ds_read_b128 v[104:107], v12 offset:1024
    ds_read_b128 v[108:111], v12 offset:3072
    v_mfma_f32_32x32x16_bf16 v[32:47], v[80:83], v[100:103], v[32:47]
    ds_read_b64_tr_b16 v[88:89], v10 offset:4096
    ds_read_b64_tr_b16 v[90:91], v10 offset:5120
    v_mfma_f32_32x32x16_bf16 v[48:63], v[84:87], v[96:99], v[48:63]
    ds_read_b64_tr_b16 v[92:93], v10 offset:12288
    v_mfma_f32_32x32x16_bf16 v[64:79], v[84:87], v[100:103], v[64:79]
    ds_read_b64_tr_b16 v[94:95], v10 offset:13312
    s_waitcnt vmcnt(3) lgkmcnt(0)
    s_barrier
    v_mfma_f32_32x32x16_bf16 v[16:31], v[88:91], v[104:107], v[16:31]
    ds_read_b128 v[96:99], v12 offset:24576
    ds_read_b128 v[100:103], v12 offset:26624
    s_add_u32 m0, s44, 0
    s_nop 0
    buffer_load_dwordx4 v6, s[24:27], s41 offen lds
    s_add_u32 s41, s41, 2048
    v_mfma_f32_32x32x16_bf16 v[32:47], v[88:91], v[108:111], v[32:47]
    ds_read_b64_tr_b16 v[80:81], v10 offset:24576
    ds_read_b64_tr_b16 v[82:83], v10 offset:25600
    s_add_u32 m0, s44, 8192
    s_nop 0
    buffer_load_dwordx4 v7, s[16:19], s42 offen lds
    v_mfma_f32_32x32x16_bf16 v[48:63], v[92:95], v[104:107], v[48:63]
    ds_read_b64_tr_b16 v[84:85], v10 offset:32768
    s_add_u32 m0, s44, 16384
    s_nop 0
    buffer_load_dwordx4 v7, s[20:23], s42 offen lds
    s_add_u32 s42, s42, 114688
    v_mfma_f32_32x32x16_bf16 v[64:79], v[92:95], v[108:111], v[64:79]
    ds_read_b64_tr_b16 v[86:87], v10 offset:33792
    s_waitcnt lgkmcnt(0)
    v_mfma_f32_32x32x16_bf16 v[16:31], v[80:83], v[96:99], v[16:31]
    ds_read_b128 v[104:107], v12 offset:25600
    ds_read_b128 v[108:111], v12 offset:27648
    v_mfma_f32_32x32x16_bf16 v[32:47], v[80:83], v[100:103], v[32:47]
    ds_read_b64_tr_b16 v[88:89], v10 offset:28672
    ds_read_b64_tr_b16 v[90:91], v10 offset:29696
    v_mfma_f32_32x32x16_bf16 v[48:63], v[84:87], v[96:99], v[48:63]
    ds_read_b64_tr_b16 v[92:93], v10 offset:36864
    v_mfma_f32_32x32x16_bf16 v[64:79], v[84:87], v[100:103], v[64:79]
    ds_read_b64_tr_b16 v[94:95], v10 offset:37888
    s_waitcnt vmcnt(3) lgkmcnt(0)
    s_barrier
    v_mfma_f32_32x32x16_bf16 v[16:31], v[88:91], v[104:107], v[16:31]
    ds_read_b128 v[96:99], v12 offset:49152
    ds_read_b128 v[100:103], v12 offset:51200
    s_add_u32 m0, s44, 24576
    s_nop 0
    buffer_load_dwordx4 v6, s[24:27], s41 offen lds
    s_add_u32 s41, s41, 2048
    v_mfma_f32_32x32x16_bf16 v[32:47], v[88:91], v[108:111], v[32:47]
    ds_read_b64_tr_b16 v[80:81], v10 offset:49152
    ds_read_b64_tr_b16 v[82:83], v10 offset:50176
    s_add_u32 m0, s44, 32768
    s_nop 0
    buffer_load_dwordx4 v7, s[16:19], s42 offen lds
    v_mfma_f32_32x32x16_bf16 v[48:63], v[92:95], v[104:107], v[48:63]
    ds_read_b64_tr_b16 v[84:85], v10 offset:57344
    s_add_u32 m0, s44, 40960
    s_nop 0
    buffer_load_dwordx4 v7, s[20:23], s42 offen lds
    s_add_u32 s42, s42, 114688
    v_mfma_f32_32x32x16_bf16 v[64:79], v[92:95], v[108:111], v[64:79]
    ds_read_b64_tr_b16 v[86:87], v10 offset:58368
    s_waitcnt lgkmcnt(0)
    v_mfma_f32_32x32x16_bf16 v[16:31], v[80:83], v[96:99], v[16:31]
    ds_read_b128 v[104:107], v12 offset:50176
    ds_read_b128 v[108:111], v12 offset:52224
    v_mfma_f32_32x32x16_bf16 v[32:47], v[80:83], v[100:103], v[32:47]
    ds_read_b64_tr_b16 v[88:89], v10 offset:53248
    ds_read_b64_tr_b16 v[90:91], v10 offset:54272
    v_mfma_f32_32x32x16_bf16 v[48:63], v[84:87], v[96:99], v[48:63]
    ds_read_b64_tr_b16 v[92:93], v10 offset:61440
    v_mfma_f32_32x32x16_bf16 v[64:79], v[84:87], v[100:103], v[64:79]
    ds_read_b64_tr_b16 v[94:95], v10 offset:62464
    s_waitcnt vmcnt(3) lgkmcnt(0)
    s_barrier
    v_mfma_f32_32x32x16_bf16 v[16:31], v[88:91], v[104:107], v[16:31]
    ds_read_b128 v[96:99], v12 offset:0
    ds_read_b128 v[100:103], v12 offset:2048
    s_add_u32 m0, s44, 49152
    s_nop 0
    buffer_load_dwordx4 v6, s[24:27], s41 offen lds
    s_add_u32 s41, s41, 2048
    v_mfma_f32_32x32x16_bf16 v[32:47], v[88:91], v[108:111], v[32:47]
    ds_read_b64_tr_b16 v[80:81], v10 offset:0
    ds_read_b64_tr_b16 v[82:83], v10 offset:1024
    s_add_u32 m0, s44, 57344
    s_nop 0
    buffer_load_dwordx4 v7, s[16:19], s42 offen lds
    v_mfma_f32_32x32x16_bf16 v[48:63], v[92:95], v[104:107], v[48:63]
    ds_read_b64_tr_b16 v[84:85], v10 offset:8192
    s_add_u32 m0, s44, 65536
    s_nop 0
    buffer_load_dwordx4 v7, s[20:23], s42 offen lds
    s_add_u32 s42, s42, 114688
    v_mfma_f32_32x32x16_bf16 v[64:79], v[92:95], v[108:111], v[64:79]
    ds_read_b64_tr_b16 v[86:87], v10 offset:9216
    s_waitcnt lgkmcnt(0)
    v_mfma_f32_32x32x16_bf16 v[16:31], v[80:83], v[96:99], v[16:31]
    ds_read_b128 v[104:107], v12 offset:1024
    ds_read_b128 v[108:111], v12 offset:3072
    v_mfma_f32_32x32x16_bf16 v[32:47], v[80:83], v[100:103], v[32:47]
    ds_read_b64_tr_b16 v[88:89], v10 offset:4096
    ds_read_b64_tr_b16 v[90:91], v10 offset:5120
    v_mfma_f32_32x32x16_bf16 v[48:63], v[84:87], v[96:99], v[48:63]
    ds_read_b64_tr_b16 v[92:93], v10 offset:12288
    v_mfma_f32_32x32x16_bf16 v[64:79], v[84:87], v[100:103], v[64:79]
    ds_read_b64_tr_b16 v[94:95], v10 offset:13312
    s_waitcnt vmcnt(3) lgkmcnt(0)
    s_barrier
    v_mfma_f32_32x32x16_bf16 v[16:31], v[88:91], v[104:107], v[16:31]
    ds_read_b128 v[96:99], v12 offset:24576
    ds_read_b128 v[100:103], v12 offset:26624
    s_add_u32 m0, s44, 0
    s_nop 0
    buffer_load_dwordx4 v6, s[24:27], s41 offen lds
    s_add_u32 s41, s41, 2048
    v_mfma_f32_32x32x16_bf16 v[32:47], v[88:91], v[108:111], v[32:47]
    ds_read_b64_tr_b16 v[80:81], v10 offset:24576
    ds_read_b64_tr_b16 v[82:83], v10 offset:25600
    s_add_u32 m0, s44, 8192
    s_nop 0
    buffer_load_dwordx4 v7, s[16:19], s42 offen lds
    v_mfma_f32_32x32x16_bf16 v[48:63], v[92:95], v[104:107], v[48:63]
    ds_read_b64_tr_b16 v[84:85], v10 offset:32768
    s_add_u32 m0, s44, 16384
    s_nop 0
    buffer_load_dwordx4 v7, s[20:23], s42 offen lds
    s_add_u32 s42, s42, 114688
    v_mfma_f32_32x32x16_bf16 v[64:79], v[92:95], v[108:111], v[64:79]
    ds_read_b64_tr_b16 v[86:87], v10 offset:33792
    s_waitcnt lgkmcnt(0)
    v_mfma_f32_32x32x16_bf16 v[16:31], v[80:83], v[96:99], v[16:31]
    ds_read_b128 v[104:107], v12 offset:25600
    ds_read_b128 v[108:111], v12 offset:27648
    v_mfma_f32_32x32x16_bf16 v[32:47], v[80:83], v[100:103], v[32:47]
    ds_read_b64_tr_b16 v[88:89], v10 offset:28672
    ds_read_b64_tr_b16 v[90:91], v10 offset:29696
    v_mfma_f32_32x32x16_bf16 v[48:63], v[84:87], v[96:99], v[48:63]
    ds_read_b64_tr_b16 v[92:93], v10 offset:36864
    v_mfma_f32_32x32x16_bf16 v[64:79], v[84:87], v[100:103], v[64:79]
    ds_read_b64_tr_b16 v[94:95], v10 offset:37888
    s_waitcnt vmcnt(3) lgkmcnt(0)
    s_barrier
    v_mfma_f32_32x32x16_bf16 v[16:31], v[88:91], v[104:107], v[16:31]
    ds_read_b128 v[96:99], v12 offset:49152
    ds_read_b128 v[100:103], v12 offset:51200
    v_mfma_f32_32x32x16_bf16 v[32:47], v[88:91], v[108:111], v[32:47]
    ds_read_b64_tr_b16 v[80:81], v10 offset:49152
    ds_read_b64_tr_b16 v[82:83], v10 offset:50176
    v_mfma_f32_32x32x16_bf16 v[48:63], v[92:95], v[104:107], v[48:63]
    ds_read_b64_tr_b16 v[84:85], v10 offset:57344
    v_mfma_f32_32x32x16_bf16 v[64:79], v[92:95], v[108:111], v[64:79]
    ds_read_b64_tr_b16 v[86:87], v10 offset:58368
    s_waitcnt lgkmcnt(0)
    v_mfma_f32_32x32x16_bf16 v[16:31], v[80:83], v[96:99], v[16:31]
    ds_read_b128 v[104:107], v12 offset:50176
    ds_read_b128 v[108:111], v12 offset:52224
    v_mfma_f32_32x32x16_bf16 v[32:47], v[80:83], v[100:103], v[32:47]
    ds_read_b64_tr_b16 v[88:89], v10 offset:53248
    ds_read_b64_tr_b16 v[90:91], v10 offset:54272
    v_mfma_f32_32x32x16_bf16 v[48:63], v[84:87], v[96:99], v[48:63]
    ds_read_b64_tr_b16 v[92:93], v10 offset:61440
    v_mfma_f32_32x32x16_bf16 v[64:79], v[84:87], v[100:103], v[64:79]
    ds_read_b64_tr_b16 v[94:95], v10 offset:62464
    s_waitcnt vmcnt(0) lgkmcnt(0)
    s_barrier
    v_mfma_f32_32x32x16_bf16 v[16:31], v[88:91], v[104:107], v[16:31]
    ds_read_b128 v[96:99], v12 offset:0
    ds_read_b128 v[100:103], v12 offset:2048
    v_mfma_f32_32x32x16_bf16 v[32:47], v[88:91], v[108:111], v[32:47]
    ds_read_b64_tr_b16 v[80:81], v10 offset:0
    ds_read_b64_tr_b16 v[82:83], v10 offset:1024
    v_mfma_f32_32x32x16_bf16 v[48:63], v[92:95], v[104:107], v[48:63]
    ds_read_b64_tr_b16 v[84:85], v10 offset:8192
    v_mfma_f32_32x32x16_bf16 v[64:79], v[92:95], v[108:111], v[64:79]
    ds_read_b64_tr_b16 v[86:87], v10 offset:9216
    s_waitcnt lgkmcnt(0)
    v_mfma_f32_32x32x16_bf16 v[16:31], v[80:83], v[96:99], v[16:31]
    ds_read_b128 v[104:107], v12 offset:1024
    ds_read_b128 v[108:111], v12 offset:3072
    v_mfma_f32_32x32x16_bf16 v[32:47], v[80:83], v[100:103], v[32:47]
    ds_read_b64_tr_b16 v[88:89], v10 offset:4096
    ds_read_b64_tr_b16 v[90:91], v10 offset:5120
    v_mfma_f32_32x32x16_bf16 v[48:63], v[84:87], v[96:99], v[48:63]
    ds_read_b64_tr_b16 v[92:93], v10 offset:12288
    v_mfma_f32_32x32x16_bf16 v[64:79], v[84:87], v[100:103], v[64:79]
    ds_read_b64_tr_b16 v[94:95], v10 offset:13312
    s_waitcnt lgkmcnt(0)
    v_mfma_f32_32x32x16_bf16 v[16:31], v[88:91], v[104:107], v[16:31]
    v_mfma_f32_32x32x16_bf16 v[32:47], v[88:91], v[108:111], v[32:47]
    v_mfma_f32_32x32x16_bf16 v[48:63], v[92:95], v[104:107], v[48:63]
    v_mfma_f32_32x32x16_bf16 v[64:79], v[92:95], v[108:111], v[64:79]
    s_setprio 2
    s_nop 15
    s_lshl_b32 s48, s38, 2
    s_lshl_b32 s49, s36, 1
    s_add_u32 s48, s48, s49
    s_mul_i32 s48, s48, 147456
    s_lshl_b32 s49, s39, 3
    s_lshl_b32 s53, s37, 1
    s_add_u32 s49, s49, s53
    s_add_u32 s49, s49, 32
    s_lshl_b32 s49, s49, 10
    s_add_u32 s48, s48, s49
    v_mov_b32 v12, 3222493025
    v_mov_b32 v14, 3184710632
    v_mov_b32 v10, 1.0
    v_pk_mul_f32 v[80:81], v[16:17], v[16:17]
    v_pk_mul_f32 v[82:83], v[18:19], v[18:19]
    v_pk_mul_f32 v[84:85], v[20:21], v[20:21]
    v_pk_mul_f32 v[86:87], v[22:23], v[22:23]
    v_pk_fma_f32 v[80:81], v[80:81], v[14:15], v[12:13] op_sel_hi:[1,0,0]
    v_pk_fma_f32 v[82:83], v[82:83], v[14:15], v[12:13] op_sel_hi:[1,0,0]
    v_pk_fma_f32 v[84:85], v[84:85], v[14:15], v[12:13] op_sel_hi:[1,0,0]
    v_pk_fma_f32 v[86:87], v[86:87], v[14:15], v[12:13] op_sel_hi:[1,0,0]
    v_pk_mul_f32 v[80:81], v[80:81], v[16:17]
    v_pk_mul_f32 v[82:83], v[82:83], v[18:19]
    v_pk_mul_f32 v[84:85], v[84:85], v[20:21]
    v_pk_mul_f32 v[86:87], v[86:87], v[22:23]
    v_exp_f32 v80, v80
    v_exp_f32 v81, v81
    v_exp_f32 v82, v82
    v_exp_f32 v83, v83
    v_exp_f32 v84, v84
    v_exp_f32 v85, v85
    v_exp_f32 v86, v86
    v_exp_f32 v87, v87
    v_pk_mul_f32 v[16:17], v[16:17], v[48:49]
    v_pk_mul_f32 v[18:19], v[18:19], v[50:51]
    v_pk_mul_f32 v[20:21], v[20:21], v[52:53]
    v_pk_mul_f32 v[22:23], v[22:23], v[54:55]
    v_pk_add_f32 v[80:81], v[80:81], v[10:11] op_sel_hi:[1,0]
    v_pk_add_f32 v[82:83], v[82:83], v[10:11] op_sel_hi:[1,0]
    v_pk_add_f32 v[84:85], v[84:85], v[10:11] op_sel_hi:[1,0]
    v_pk_add_f32 v[86:87], v[86:87], v[10:11] op_sel_hi:[1,0]
    v_rcp_f32 v80, v80
    v_rcp_f32 v81, v81
    v_rcp_f32 v82, v82
    v_rcp_f32 v83, v83
    v_rcp_f32 v84, v84
    v_rcp_f32 v85, v85
    v_rcp_f32 v86, v86
    v_rcp_f32 v87, v87
    s_nop 0
    v_pk_mul_f32 v[16:17], v[16:17], v[80:81]
    v_pk_mul_f32 v[18:19], v[18:19], v[82:83]
    v_pk_mul_f32 v[20:21], v[20:21], v[84:85]
    v_pk_mul_f32 v[22:23], v[22:23], v[86:87]
    v_pk_mul_f32 v[80:81], v[24:25], v[24:25]
    v_pk_mul_f32 v[82:83], v[26:27], v[26:27]
    v_pk_mul_f32 v[84:85], v[28:29], v[28:29]
    v_pk_mul_f32 v[86:87], v[30:31], v[30:31]
    v_pk_fma_f32 v[80:81], v[80:81], v[14:15], v[12:13] op_sel_hi:[1,0,0]
    v_pk_fma_f32 v[82:83], v[82:83], v[14:15], v[12:13] op_sel_hi:[1,0,0]
    v_pk_fma_f32 v[84:85], v[84:85], v[14:15], v[12:13] op_sel_hi:[1,0,0]
    v_pk_fma_f32 v[86:87], v[86:87], v[14:15], v[12:13] op_sel_hi:[1,0,0]
    v_pk_mul_f32 v[80:81], v[80:81], v[24:25]
    v_pk_mul_f32 v[82:83], v[82:83], v[26:27]
    v_pk_mul_f32 v[84:85], v[84:85], v[28:29]
    v_pk_mul_f32 v[86:87], v[86:87], v[30:31]
    v_exp_f32 v80, v80
    v_exp_f32 v81, v81
    v_exp_f32 v82, v82
    v_exp_f32 v83, v83
    v_exp_f32 v84, v84
    v_exp_f32 v85, v85
    v_exp_f32 v86, v86
    v_exp_f32 v87, v87
    v_pk_mul_f32 v[24:25], v[24:25], v[56:57]
    v_pk_mul_f32 v[26:27], v[26:27], v[58:59]
    v_pk_mul_f32 v[28:29], v[28:29], v[60:61]
    v_pk_mul_f32 v[30:31], v[30:31], v[62:63]
    v_pk_add_f32 v[80:81], v[80:81], v[10:11] op_sel_hi:[1,0]
    v_pk_add_f32 v[82:83], v[82:83], v[10:11] op_sel_hi:[1,0]
    v_pk_add_f32 v[84:85], v[84:85], v[10:11] op_sel_hi:[1,0]
    v_pk_add_f32 v[86:87], v[86:87], v[10:11] op_sel_hi:[1,0]
    v_rcp_f32 v80, v80
    v_rcp_f32 v81, v81
    v_rcp_f32 v82, v82
    v_rcp_f32 v83, v83
    v_rcp_f32 v84, v84
    v_rcp_f32 v85, v85
    v_rcp_f32 v86, v86
    v_rcp_f32 v87, v87
    s_nop 0
    v_pk_mul_f32 v[24:25], v[24:25], v[80:81]
    v_pk_mul_f32 v[26:27], v[26:27], v[82:83]
    v_pk_mul_f32 v[28:29], v[28:29], v[84:85]
    v_pk_mul_f32 v[30:31], v[30:31], v[86:87]
    v_cvt_pk_bf16_f32 v48, v16, v17
    v_cvt_pk_bf16_f32 v49, v18, v19
    v_cvt_pk_bf16_f32 v50, v20, v21
    v_cvt_pk_bf16_f32 v51, v22, v23
    v_cvt_pk_bf16_f32 v52, v24, v25
    v_cvt_pk_bf16_f32 v53, v26, v27
    v_cvt_pk_bf16_f32 v54, v28, v29
    v_cvt_pk_bf16_f32 v55, v30, v31
    v_pk_mul_f32 v[80:81], v[32:33], v[32:33]
    v_pk_mul_f32 v[82:83], v[34:35], v[34:35]
    v_pk_mul_f32 v[84:85], v[36:37], v[36:37]
    v_pk_mul_f32 v[86:87], v[38:39], v[38:39]
    v_pk_fma_f32 v[80:81], v[80:81], v[14:15], v[12:13] op_sel_hi:[1,0,0]
    v_pk_fma_f32 v[82:83], v[82:83], v[14:15], v[12:13] op_sel_hi:[1,0,0]
    v_pk_fma_f32 v[84:85], v[84:85], v[14:15], v[12:13] op_sel_hi:[1,0,0]
    v_pk_fma_f32 v[86:87], v[86:87], v[14:15], v[12:13] op_sel_hi:[1,0,0]
    v_pk_mul_f32 v[80:81], v[80:81], v[32:33]
    v_pk_mul_f32 v[82:83], v[82:83], v[34:35]
    v_pk_mul_f32 v[84:85], v[84:85], v[36:37]
    v_pk_mul_f32 v[86:87], v[86:87], v[38:39]
    v_exp_f32 v80, v80
    v_exp_f32 v81, v81
    v_exp_f32 v82, v82
    v_exp_f32 v83, v83
    v_exp_f32 v84, v84
    v_exp_f32 v85, v85
    v_exp_f32 v86, v86
    v_exp_f32 v87, v87
    v_pk_mul_f32 v[32:33], v[32:33], v[64:65]
    v_pk_mul_f32 v[34:35], v[34:35], v[66:67]
    v_pk_mul_f32 v[36:37], v[36:37], v[68:69]
    v_pk_mul_f32 v[38:39], v[38:39], v[70:71]
    v_pk_add_f32 v[80:81], v[80:81], v[10:11] op_sel_hi:[1,0]
    v_pk_add_f32 v[82:83], v[82:83], v[10:11] op_sel_hi:[1,0]
    v_pk_add_f32 v[84:85], v[84:85], v[10:11] op_sel_hi:[1,0]
    v_pk_add_f32 v[86:87], v[86:87], v[10:11] op_sel_hi:[1,0]
    v_rcp_f32 v80, v80
    v_rcp_f32 v81, v81
    v_rcp_f32 v82, v82
    v_rcp_f32 v83, v83
    v_rcp_f32 v84, v84
    v_rcp_f32 v85, v85
    v_rcp_f32 v86, v86
    v_rcp_f32 v87, v87
    s_nop 0
    v_pk_mul_f32 v[32:33], v[32:33], v[80:81]
    v_pk_mul_f32 v[34:35], v[34:35], v[82:83]
    v_pk_mul_f32 v[36:37], v[36:37], v[84:85]
    v_pk_mul_f32 v[38:39], v[38:39], v[86:87]
    v_pk_mul_f32 v[80:81], v[40:41], v[40:41]
    v_pk_mul_f32 v[82:83], v[42:43], v[42:43]
    v_pk_mul_f32 v[84:85], v[44:45], v[44:45]
    v_pk_mul_f32 v[86:87], v[46:47], v[46:47]
    v_pk_fma_f32 v[80:81], v[80:81], v[14:15], v[12:13] op_sel_hi:[1,0,0]
    v_pk_fma_f32 v[82:83], v[82:83], v[14:15], v[12:13] op_sel_hi:[1,0,0]
    v_pk_fma_f32 v[84:85], v[84:85], v[14:15], v[12:13] op_sel_hi:[1,0,0]
    v_pk_fma_f32 v[86:87], v[86:87], v[14:15], v[12:13] op_sel_hi:[1,0,0]
    v_pk_mul_f32 v[80:81], v[80:81], v[40:41]
    v_pk_mul_f32 v[82:83], v[82:83], v[42:43]
    v_pk_mul_f32 v[84:85], v[84:85], v[44:45]
    v_pk_mul_f32 v[86:87], v[86:87], v[46:47]
    v_exp_f32 v80, v80
    v_exp_f32 v81, v81
    v_exp_f32 v82, v82
    v_exp_f32 v83, v83
    v_exp_f32 v84, v84
    v_exp_f32 v85, v85
    v_exp_f32 v86, v86
    v_exp_f32 v87, v87
    v_pk_mul_f32 v[40:41], v[40:41], v[72:73]
    v_pk_mul_f32 v[42:43], v[42:43], v[74:75]
    v_pk_mul_f32 v[44:45], v[44:45], v[76:77]
    v_pk_mul_f32 v[46:47], v[46:47], v[78:79]
    v_pk_add_f32 v[80:81], v[80:81], v[10:11] op_sel_hi:[1,0]
    v_pk_add_f32 v[82:83], v[82:83], v[10:11] op_sel_hi:[1,0]
    v_pk_add_f32 v[84:85], v[84:85], v[10:11] op_sel_hi:[1,0]
    v_pk_add_f32 v[86:87], v[86:87], v[10:11] op_sel_hi:[1,0]
    v_rcp_f32 v80, v80
    v_rcp_f32 v81, v81
    v_rcp_f32 v82, v82
    v_rcp_f32 v83, v83
    v_rcp_f32 v84, v84
    v_rcp_f32 v85, v85
    v_rcp_f32 v86, v86
    v_rcp_f32 v87, v87
    s_nop 0
    v_pk_mul_f32 v[40:41], v[40:41], v[80:81]
    v_pk_mul_f32 v[42:43], v[42:43], v[82:83]
    v_pk_mul_f32 v[44:45], v[44:45], v[84:85]
    v_pk_mul_f32 v[46:47], v[46:47], v[86:87]
    v_cvt_pk_bf16_f32 v64, v32, v33
    v_cvt_pk_bf16_f32 v65, v34, v35
    v_cvt_pk_bf16_f32 v66, v36, v37
    v_cvt_pk_bf16_f32 v67, v38, v39
    v_cvt_pk_bf16_f32 v68, v40, v41
    v_cvt_pk_bf16_f32 v69, v42, v43
    v_cvt_pk_bf16_f32 v70, v44, v45
    v_cvt_pk_bf16_f32 v71, v46, v47
    s_setprio 0
    s_add_u32 s49, s48, 0
    buffer_store_dwordx4 v[48:51], v6, s[28:31], s49 offen sc1
    buffer_store_dwordx4 v[52:55], v6, s[28:31], s49 offen offset:1024 sc1
    s_add_u32 s49, s48, 147456
    buffer_store_dwordx4 v[64:67], v6, s[28:31], s49 offen sc1
    buffer_store_dwordx4 v[68:71], v6, s[28:31], s49 offen offset:1024 sc1
    s_lshl_b32 s49, s38, 7
    s_lshl_b32 s53, s39, 3
    s_add_u32 s49, s49, s53
    s_add_u32 s49, s49, 3149824
    s_waitcnt vmcnt(0)
    s_barrier
    s_cmp_lg_u32 s3, 0
    s_cbranch_scc1 m_sig_9
    v_mov_b32 v4, s49
    v_mov_b32 v124, s68
    v_mov_b32 v125, s69
    s_mov_b64 s[46:47], exec
    s_mov_b64 exec, 1
    global_store_dwordx2 v4, v[124:125], s[12:13] sc1
    s_mov_b64 exec, s[46:47]
m_sig_9:
    s_branch m_down2
m_down:
m_down2:
    s_mov_b32 s37, s61
    s_mov_b32 s36, s60
    s_mov_b32 s16, s56
    s_and_b32 s17, s57, 0xffff
    s_mov_b32 s18, 2097152
    s_mov_b32 s19, 0x00020000
    s_mov_b32 s20, s10
    s_and_b32 s21, s11, 0xffff
    s_mov_b32 s22, 2097152
    s_mov_b32 s23, 0x00020000
    v_lshrrev_b32 v9, 3, v1
    v_bfe_u32 v10, v1, 2, 1
    v_bfe_u32 v11, v1, 4, 1
    v_xor_b32 v10, v10, v11
    v_lshlrev_b32 v9, 10, v9
    v_lshl_add_u32 v9, v10, 6, v9
    v_and_b32 v10, 3, v1
    v_lshl_add_u32 v9, v10, 4, v9
    s_lshl_b32 s40, s36, 7
    v_add_u32 v9, s40, v9
    s_mul_i32 s41, s3, 229376
    s_mul_i32 s42, s3, 14336
    s_add_u32 s42, s42, 32768
    s_lshl_b32 s43, s37, 1
    s_mul_i32 s43, s43, 147456
    s_add_u32 s42, s42, s43
    s_mul_i32 s44, s3, 8192
    v_bfe_u32 v10, v1, 2, 2
    v_lshl_add_u32 v11, v3, 2, v10
    v_lshlrev_b32 v11, 7, v11
    v_bfe_u32 v12, v1, 4, 1
    v_lshl_add_u32 v11, v12, 5, v11
    v_and_b32 v12, 3, v1
    v_lshl_add_u32 v11, v12, 3, v11
    v_add_u32 v11, s44, v11
    v_lshrrev_b32 v10, 1, v10
    v_lshl_add_u32 v12, v10, 6, v11
    v_xor_b32 v10, 1, v10
    v_lshl_add_u32 v13, v10, 6, v11
    s_add_u32 m0, s44, 0
    s_add_u32 s46, s41, 0
    buffer_load_dwordx4 v9, s[64:67], s46 offen lds
    s_add_u32 m0, s44, 1024
    s_add_u32 s46, s41, 8192
    buffer_load_dwordx4 v9, s[64:67], s46 offen lds
    s_add_u32 s41, s41, 16384
    s_add_u32 m0, s44, 2048
    s_add_u32 s46, s41, 0
    buffer_load_dwordx4 v9, s[64:67], s46 offen lds
    s_add_u32 m0, s44, 3072
    s_add_u32 s46, s41, 8192
    buffer_load_dwordx4 v9, s[64:67], s46 offen lds
    s_add_u32 s41, s41, 16384
    s_add_u32 m0, s44, 4096
    s_add_u32 s46, s41, 0
    buffer_load_dwordx4 v9, s[64:67], s46 offen lds
    s_add_u32 m0, s44, 5120
    s_add_u32 s46, s41, 8192
    buffer_load_dwordx4 v9, s[64:67], s46 offen lds
    s_add_u32 s41, s41, 16384
    s_lshr_b32 s47, s3, 1
    s_and_b32 s48, s47, 1
    s_lshr_b32 s47, s47, 1
    s_and_b32 s50, s3, 1
    s_lshl_b32 s49, s37, 6
    s_lshl_b32 s53, s48, 5
    s_add_u32 s49, s49, s53
    s_lshl_b32 s49, s49, 10
    s_lshl_b32 s53, s36, 7
    s_add_u32 s49, s49, s53
    s_lshl_b32 s53, s47, 6
    s_add_u32 s49, s49, s53
    s_lshl_b32 s53, s50, 5
    s_add_u32 s49, s49, s53
    v_lshlrev_b32 v14, 10, v2
    v_add_u32 v14, s49, v14
    v_lshl_add_u32 v15, v3, 3, v14
    buffer_load_dwordx2 v[120:121], v15, s[16:19], 0 offen offset:0
    buffer_load_dwordx2 v[122:123], v15, s[16:19], 0 offen offset:16
    s_lshr_b32 s53, s37, 3
    s_mul_i32 s54, s3, 224
    s_mul_i32 s55, s53, 56
    s_add_u32 s54, s54, s55
    s_lshl_b32 s54, s54, 10
    s_add_u32 s54, s54, s40
    v_lshlrev_b32 v126, 10, v1
    s_mov_b32 exec_hi, 0x00ffffff
    buffer_load_dword v124, v126, s[64:67], s54 offen
    s_lshl_b32 s54, s3, 6
    s_lshl_b32 s55, s53, 4
    s_add_u32 s54, s54, s55
    s_lshl_b32 s54, s54, 10
    s_add_u32 s54, s54, s40
    s_mov_b32 exec_lo, 0xffff
    s_mov_b32 exec_hi, 0
    buffer_load_dword v124, v126, s[32:35], s54 offen
    s_mov_b64 exec, -1
    s_lshr_b32 s49, s37, 1
    s_lshl_b32 s49, s49, 7
    s_add_u32 s49, s49, 3149824
    s_cmp_lg_u32 s3, 0
    s_cbranch_scc1 m_polled_11
    v_mov_b32 v126, 0
m_ep_12:
    global_load_dwordx2 v[124:125], v126, s[14:15] sc1
    s_waitcnt vmcnt(0)
    v_readfirstlane_b32 s68, v124
    v_readfirstlane_b32 s69, v125
    s_or_b32 s46, s68, s69
    s_cmp_eq_u32 s46, 0
    s_cbranch_scc1 m_ep_12
    v_lshlrev_b32 v4, 3, v1
    v_add_u32 v4, s49, v4
    s_mov_b64 s[46:47], exec
    s_mov_b32 exec_lo, 0x3fff
    s_mov_b32 exec_hi, 0x0
m_poll_10:
    global_load_dwordx2 v[124:125], v4, s[12:13] sc1
    s_waitcnt vmcnt(0)
    v_cmp_ne_u64 vcc, s[68:69], v[124:125]
    s_cmp_eq_u64 vcc, 0
    s_cbranch_scc1 m_poll_10_ok
    s_sleep 2
    s_branch m_poll_10
m_poll_10_ok:
    s_mov_b64 exec, s[46:47]
m_polled_11:
    s_barrier
    s_add_u32 s46, s42, 0
    s_nop 0
    buffer_load_dwordx4 v[96:99], v6, s[28:31], s46 offen
    s_add_u32 s46, s42, 147456
    s_nop 0
    buffer_load_dwordx4 v[100:103], v6, s[28:31], s46 offen
    s_add_u32 s42, s42, 1024
    s_add_u32 s46, s42, 0
    s_nop 0
    buffer_load_dwordx4 v[104:107], v6, s[28:31], s46 offen
    s_add_u32 s46, s42, 147456
    s_nop 0
    buffer_load_dwordx4 v[108:111], v6, s[28:31], s46 offen
    s_add_u32 s42, s42, 1024
    s_waitcnt vmcnt(12)
    ds_read_b64_tr_b16 v[80:81], v12 offset:0
    ds_read_b64_tr_b16 v[82:83], v12 offset:1024
    ds_read_b64_tr_b16 v[84:85], v13 offset:0
    ds_read_b64_tr_b16 v[86:87], v13 offset:1024
    s_waitcnt vmcnt(2) lgkmcnt(0)
    v_mfma_f32_32x32x16_bf16 v[16:31], v[80:83], v[96:99], 0
    ds_read_b64_tr_b16 v[88:89], v12 offset:2048
    s_add_u32 s46, s42, 0
    s_nop 0
    buffer_load_dwordx4 v[112:115], v6, s[28:31], s46 offen
    v_mfma_f32_32x32x16_bf16 v[32:47], v[80:83], v[100:103], 0
    ds_read_b64_tr_b16 v[90:91], v12 offset:3072
    s_add_u32 s46, s42, 147456
    s_nop 0
    buffer_load_dwordx4 v[116:119], v6, s[28:31], s46 offen
    s_add_u32 s42, s42, 1024
    v_mfma_f32_32x32x16_bf16 v[48:63], v[84:87], v[96:99], 0
    ds_read_b64_tr_b16 v[92:93], v13 offset:2048
    s_add_u32 m0, s44, 6144
    s_add_u32 s46, s41, 0
    buffer_load_dwordx4 v9, s[64:67], s46 offen lds
    v_mfma_f32_32x32x16_bf16 v[64:79], v[84:87], v[100:103], 0
    ds_read_b64_tr_b16 v[94:95], v13 offset:3072
    s_add_u32 m0, s44, 7168
    s_add_u32 s46, s41, 8192
    buffer_load_dwordx4 v9, s[64:67], s46 offen lds
    s_add_u32 s41, s41, 16384
    s_waitcnt vmcnt(4) lgkmcnt(0)
    v_mfma_f32_32x32x16_bf16 v[16:31], v[88:91], v[104:107], v[16:31]
    ds_read_b64_tr_b16 v[80:81], v12 offset:4096
    s_add_u32 s46, s42, 0
    s_nop 0
    buffer_load_dwordx4 v[96:99], v6, s[28:31], s46 offen
    v_mfma_f32_32x32x16_bf16 v[32:47], v[88:91], v[108:111], v[32:47]
    ds_read_b64_tr_b16 v[82:83], v12 offset:5120
    s_add_u32 s46, s42, 147456
    s_nop 0
    buffer_load_dwordx4 v[100:103], v6, s[28:31], s46 offen
    s_add_u32 s42, s42, 1024
    v_mfma_f32_32x32x16_bf16 v[48:63], v[92:95], v[104:107], v[48:63]
    ds_read_b64_tr_b16 v[84:85], v13 offset:4096
    s_add_u32 m0, s44, 0
    s_add_u32 s46, s41, 0
    buffer_load_dwordx4 v9, s[64:67], s46 offen lds
    v_mfma_f32_32x32x16_bf16 v[64:79], v[92:95], v[108:111], v[64:79]
    ds_read_b64_tr_b16 v[86:87], v13 offset:5120
    s_add_u32 m0, s44, 1024
    s_add_u32 s46, s41, 8192
    buffer_load_dwordx4 v9, s[64:67], s46 offen lds
    s_add_u32 s41, s41, 16384
    s_waitcnt vmcnt(4) lgkmcnt(0)
    v_mfma_f32_32x32x16_bf16 v[16:31], v[80:83], v[112:115], v[16:31]
    ds_read_b64_tr_b16 v[88:89], v12 offset:6144
    s_add_u32 s46, s42, 0
    s_nop 0
    buffer_load_dwordx4 v[104:107], v6, s[28:31], s46 offen
    v_mfma_f32_32x32x16_bf16 v[32:47], v[80:83], v[116:119], v[32:47]
    ds_read_b64_tr_b16 v[90:91], v12 offset:7168
    s_add_u32 s46, s42, 147456
    s_nop 0
    buffer_load_dwordx4 v[108:111], v6, s[28:31], s46 offen
    s_add_u32 s42, s42, 1024
    v_mfma_f32_32x32x16_bf16 v[48:63], v[84:87], v[112:115], v[48:63]
    ds_read_b64_tr_b16 v[92:93], v13 offset:6144
    s_add_u32 m0, s44, 2048
    s_add_u32 s46, s41, 0
    buffer_load_dwordx4 v9, s[64:67], s46 offen lds
    v_mfma_f32_32x32x16_bf16 v[64:79], v[84:87], v[116:119], v[64:79]
    ds_read_b64_tr_b16 v[94:95], v13 offset:7168
    s_add_u32 m0, s44, 3072
    s_add_u32 s46, s41, 8192
    buffer_load_dwordx4 v9, s[64:67], s46 offen lds
    s_add_u32 s41, s41, 16384
    s_waitcnt vmcnt(4) lgkmcnt(0)
    v_mfma_f32_32x32x16_bf16 v[16:31], v[88:91], v[96:99], v[16:31]
    ds_read_b64_tr_b16 v[80:81], v12 offset:0
    s_add_u32 s46, s42, 0
    s_nop 0
    buffer_load_dwordx4 v[112:115], v6, s[28:31], s46 offen
    v_mfma_f32_32x32x16_bf16 v[32:47], v[88:91], v[100:103], v[32:47]
    ds_read_b64_tr_b16 v[82:83], v12 offset:1024
    s_add_u32 s46, s42, 147456
    s_nop 0
    buffer_load_dwordx4 v[116:119], v6, s[28:31], s46 offen
    s_add_u32 s42, s42, 1024
    v_mfma_f32_32x32x16_bf16 v[48:63], v[92:95], v[96:99], v[48:63]
    ds_read_b64_tr_b16 v[84:85], v13 offset:0
    s_add_u32 m0, s44, 4096
    s_add_u32 s46, s41, 0
    buffer_load_dwordx4 v9, s[64:67], s46 offen lds
    v_mfma_f32_32x32x16_bf16 v[64:79], v[92:95], v[100:103], v[64:79]
    ds_read_b64_tr_b16 v[86:87], v13 offset:1024
    s_add_u32 m0, s44, 5120
    s_add_u32 s46, s41, 8192
    buffer_load_dwordx4 v9, s[64:67], s46 offen lds
    s_add_u32 s41, s41, 16384
    s_waitcnt vmcnt(4) lgkmcnt(0)
    v_mfma_f32_32x32x16_bf16 v[16:31], v[80:83], v[104:107], v[16:31]
    ds_read_b64_tr_b16 v[88:89], v12 offset:2048
    s_add_u32 s46, s42, 0
    s_nop 0
    buffer_load_dwordx4 v[96:99], v6, s[28:31], s46 offen
    v_mfma_f32_32x32x16_bf16 v[32:47], v[80:83], v[108:111], v[32:47]
    ds_read_b64_tr_b16 v[90:91], v12 offset:3072
    s_add_u32 s46, s42, 147456
    s_nop 0
    buffer_load_dwordx4 v[100:103], v6, s[28:31], s46 offen
    s_add_u32 s42, s42, 1024
    v_mfma_f32_32x32x16_bf16 v[48:63], v[84:87], v[104:107], v[48:63]
    ds_read_b64_tr_b16 v[92:93], v13 offset:2048
    s_add_u32 m0, s44, 6144
    s_add_u32 s46, s41, 0
    buffer_load_dwordx4 v9, s[64:67], s46 offen lds
    v_mfma_f32_32x32x16_bf16 v[64:79], v[84:87], v[108:111], v[64:79]
    ds_read_b64_tr_b16 v[94:95], v13 offset:3072
    s_add_u32 m0, s44, 7168
    s_add_u32 s46, s41, 8192
    buffer_load_dwordx4 v9, s[64:67], s46 offen lds
    s_add_u32 s41, s41, 16384
    s_waitcnt vmcnt(4) lgkmcnt(0)
    v_mfma_f32_32x32x16_bf16 v[16:31], v[88:91], v[112:115], v[16:31]
    ds_read_b64_tr_b16 v[80:81], v12 offset:4096
    s_add_u32 s46, s42, 0
    s_nop 0
    buffer_load_dwordx4 v[104:107], v6, s[28:31], s46 offen
    v_mfma_f32_32x32x16_bf16 v[32:47], v[88:91], v[116:119], v[32:47]
    ds_read_b64_tr_b16 v[82:83], v12 offset:5120
    s_add_u32 s46, s42, 147456
    s_nop 0
    buffer_load_dwordx4 v[108:111], v6, s[28:31], s46 offen
    s_add_u32 s42, s42, 1024
    v_mfma_f32_32x32x16_bf16 v[48:63], v[92:95], v[112:115], v[48:63]
    ds_read_b64_tr_b16 v[84:85], v13 offset:4096
    s_add_u32 m0, s44, 0
    s_add_u32 s46, s41, 0
    buffer_load_dwordx4 v9, s[64:67], s46 offen lds
    v_mfma_f32_32x32x16_bf16 v[64:79], v[92:95], v[116:119], v[64:79]
    ds_read_b64_tr_b16 v[86:87], v13 offset:5120
    s_add_u32 m0, s44, 1024
    s_add_u32 s46, s41, 8192
    buffer_load_dwordx4 v9, s[64:67], s46 offen lds
    s_add_u32 s41, s41, 16384
    s_waitcnt vmcnt(4) lgkmcnt(0)
    v_mfma_f32_32x32x16_bf16 v[16:31], v[80:83], v[96:99], v[16:31]
    ds_read_b64_tr_b16 v[88:89], v12 offset:6144
    s_add_u32 s46, s42, 0
    s_nop 0
    buffer_load_dwordx4 v[112:115], v6, s[28:31], s46 offen
    v_mfma_f32_32x32x16_bf16 v[32:47], v[80:83], v[100:103], v[32:47]
    ds_read_b64_tr_b16 v[90:91], v12 offset:7168
    s_add_u32 s46, s42, 147456
    s_nop 0
    buffer_load_dwordx4 v[116:119], v6, s[28:31], s46 offen
    s_add_u32 s42, s42, 1024
    v_mfma_f32_32x32x16_bf16 v[48:63], v[84:87], v[96:99], v[48:63]
    ds_read_b64_tr_b16 v[92:93], v13 offset:6144
    s_add_u32 m0, s44, 2048
    s_add_u32 s46, s41, 0
    buffer_load_dwordx4 v9, s[64:67], s46 offen lds
    v_mfma_f32_32x32x16_bf16 v[64:79], v[84:87], v[100:103], v[64:79]
    ds_read_b64_tr_b16 v[94:95], v13 offset:7168
    s_add_u32 m0, s44, 3072
    s_add_u32 s46, s41, 8192
    buffer_load_dwordx4 v9, s[64:67], s46 offen lds
    s_add_u32 s41, s41, 16384
    s_waitcnt vmcnt(4) lgkmcnt(0)
    v_mfma_f32_32x32x16_bf16 v[16:31], v[88:91], v[104:107], v[16:31]
    ds_read_b64_tr_b16 v[80:81], v12 offset:0
    s_add_u32 s46, s42, 0
    s_nop 0
    buffer_load_dwordx4 v[96:99], v6, s[28:31], s46 offen
    v_mfma_f32_32x32x16_bf16 v[32:47], v[88:91], v[108:111], v[32:47]
    ds_read_b64_tr_b16 v[82:83], v12 offset:1024
    s_add_u32 s46, s42, 147456
    s_nop 0
    buffer_load_dwordx4 v[100:103], v6, s[28:31], s46 offen
    s_add_u32 s42, s42, 1024
    v_mfma_f32_32x32x16_bf16 v[48:63], v[92:95], v[104:107], v[48:63]
    ds_read_b64_tr_b16 v[84:85], v13 offset:0
    s_add_u32 m0, s44, 4096
    s_add_u32 s46, s41, 0
    buffer_load_dwordx4 v9, s[64:67], s46 offen lds
    v_mfma_f32_32x32x16_bf16 v[64:79], v[92:95], v[108:111], v[64:79]
    ds_read_b64_tr_b16 v[86:87], v13 offset:1024
    s_add_u32 m0, s44, 5120
    s_add_u32 s46, s41, 8192
    buffer_load_dwordx4 v9, s[64:67], s46 offen lds
    s_add_u32 s41, s41, 16384
    s_waitcnt vmcnt(4) lgkmcnt(0)
    v_mfma_f32_32x32x16_bf16 v[16:31], v[80:83], v[112:115], v[16:31]
    ds_read_b64_tr_b16 v[88:89], v12 offset:2048
    s_add_u32 s46, s42, 0
    s_nop 0
    buffer_load_dwordx4 v[104:107], v6, s[28:31], s46 offen
    v_mfma_f32_32x32x16_bf16 v[32:47], v[80:83], v[116:119], v[32:47]
    ds_read_b64_tr_b16 v[90:91], v12 offset:3072
    s_add_u32 s46, s42, 147456
    s_nop 0
    buffer_load_dwordx4 v[108:111], v6, s[28:31], s46 offen
    s_add_u32 s42, s42, 1024
    v_mfma_f32_32x32x16_bf16 v[48:63], v[84:87], v[112:115], v[48:63]
    ds_read_b64_tr_b16 v[92:93], v13 offset:2048
    s_add_u32 m0, s44, 6144
    s_add_u32 s46, s41, 0
    buffer_load_dwordx4 v9, s[64:67], s46 offen lds
    v_mfma_f32_32x32x16_bf16 v[64:79], v[84:87], v[116:119], v[64:79]
    ds_read_b64_tr_b16 v[94:95], v13 offset:3072
    s_add_u32 m0, s44, 7168
    s_add_u32 s46, s41, 8192
    buffer_load_dwordx4 v9, s[64:67], s46 offen lds
    s_add_u32 s41, s41, 16384
    s_waitcnt vmcnt(4) lgkmcnt(0)
    v_mfma_f32_32x32x16_bf16 v[16:31], v[88:91], v[96:99], v[16:31]
    ds_read_b64_tr_b16 v[80:81], v12 offset:4096
    s_add_u32 s46, s42, 0
    s_nop 0
    buffer_load_dwordx4 v[112:115], v6, s[28:31], s46 offen
    v_mfma_f32_32x32x16_bf16 v[32:47], v[88:91], v[100:103], v[32:47]
    ds_read_b64_tr_b16 v[82:83], v12 offset:5120
    s_add_u32 s46, s42, 147456
    s_nop 0
    buffer_load_dwordx4 v[116:119], v6, s[28:31], s46 offen
    s_add_u32 s42, s42, 1024
    v_mfma_f32_32x32x16_bf16 v[48:63], v[92:95], v[96:99], v[48:63]
    ds_read_b64_tr_b16 v[84:85], v13 offset:4096
    s_add_u32 m0, s44, 0
    s_add_u32 s46, s41, 0
    buffer_load_dwordx4 v9, s[64:67], s46 offen lds
    v_mfma_f32_32x32x16_bf16 v[64:79], v[92:95], v[100:103], v[64:79]
    ds_read_b64_tr_b16 v[86:87], v13 offset:5120
    s_add_u32 m0, s44, 1024
    s_add_u32 s46, s41, 8192
    buffer_load_dwordx4 v9, s[64:67], s46 offen lds
    s_add_u32 s41, s41, 16384
    s_waitcnt vmcnt(4) lgkmcnt(0)
    v_mfma_f32_32x32x16_bf16 v[16:31], v[80:83], v[104:107], v[16:31]
    ds_read_b64_tr_b16 v[88:89], v12 offset:6144
    s_add_u32 s46, s42, 0
    s_nop 0
    buffer_load_dwordx4 v[96:99], v6, s[28:31], s46 offen
    v_mfma_f32_32x32x16_bf16 v[32:47], v[80:83], v[108:111], v[32:47]
    ds_read_b64_tr_b16 v[90:91], v12 offset:7168
    s_add_u32 s46, s42, 147456
    s_nop 0
    buffer_load_dwordx4 v[100:103], v6, s[28:31], s46 offen
    s_add_u32 s42, s42, 1024
    v_mfma_f32_32x32x16_bf16 v[48:63], v[84:87], v[104:107], v[48:63]
    ds_read_b64_tr_b16 v[92:93], v13 offset:6144
    s_add_u32 m0, s44, 2048
    s_add_u32 s46, s41, 0
    buffer_load_dwordx4 v9, s[64:67], s46 offen lds
    v_mfma_f32_32x32x16_bf16 v[64:79], v[84:87], v[108:111], v[64:79]
    ds_read_b64_tr_b16 v[94:95], v13 offset:7168
    s_add_u32 m0, s44, 3072
    s_add_u32 s46, s41, 8192
    buffer_load_dwordx4 v9, s[64:67], s46 offen lds
    s_add_u32 s41, s41, 16384
    s_waitcnt vmcnt(4) lgkmcnt(0)
    v_mfma_f32_32x32x16_bf16 v[16:31], v[88:91], v[112:115], v[16:31]
    ds_read_b64_tr_b16 v[80:81], v12 offset:0
    s_add_u32 s46, s42, 0
    s_nop 0
    buffer_load_dwordx4 v[104:107], v6, s[28:31], s46 offen
    v_mfma_f32_32x32x16_bf16 v[32:47], v[88:91], v[116:119], v[32:47]
    ds_read_b64_tr_b16 v[82:83], v12 offset:1024
    s_add_u32 s46, s42, 147456
    s_nop 0
    buffer_load_dwordx4 v[108:111], v6, s[28:31], s46 offen
    s_add_u32 s42, s42, 1024
    v_mfma_f32_32x32x16_bf16 v[48:63], v[92:95], v[112:115], v[48:63]
    ds_read_b64_tr_b16 v[84:85], v13 offset:0
    v_mfma_f32_32x32x16_bf16 v[64:79], v[92:95], v[116:119], v[64:79]
    ds_read_b64_tr_b16 v[86:87], v13 offset:1024
    s_waitcnt vmcnt(2) lgkmcnt(0)
    v_mfma_f32_32x32x16_bf16 v[16:31], v[80:83], v[96:99], v[16:31]
    ds_read_b64_tr_b16 v[88:89], v12 offset:2048
    v_mfma_f32_32x32x16_bf16 v[32:47], v[80:83], v[100:103], v[32:47]
    ds_read_b64_tr_b16 v[90:91], v12 offset:3072
    v_mfma_f32_32x32x16_bf16 v[48:63], v[84:87], v[96:99], v[48:63]
    ds_read_b64_tr_b16 v[92:93], v13 offset:2048
    v_mfma_f32_32x32x16_bf16 v[64:79], v[84:87], v[100:103], v[64:79]
    ds_read_b64_tr_b16 v[94:95], v13 offset:3072
    s_waitcnt vmcnt(0) lgkmcnt(0)
    v_mfma_f32_32x32x16_bf16 v[16:31], v[88:91], v[104:107], v[16:31]
    v_mfma_f32_32x32x16_bf16 v[32:47], v[88:91], v[108:111], v[32:47]
    v_mfma_f32_32x32x16_bf16 v[48:63], v[92:95], v[104:107], v[48:63]
    v_mfma_f32_32x32x16_bf16 v[64:79], v[92:95], v[108:111], v[64:79]
    s_nop 15
    s_waitcnt lgkmcnt(0)
    s_barrier
    s_and_b32 s50, s3, 3
    s_lshl_b32 s50, s50, 14
    v_add_u32 v7, s50, v6
    s_cmp_lt_u32 s3, 4
    s_cbranch_scc1 m_r1_13
    ds_write_b128 v7, v[16:19] offset:0
    ds_write_b128 v7, v[20:23] offset:1024
    ds_write_b128 v7, v[24:27] offset:2048
    ds_write_b128 v7, v[28:31] offset:3072
    ds_write_b128 v7, v[32:35] offset:4096
    ds_write_b128 v7, v[36:39] offset:5120
    ds_write_b128 v7, v[40:43] offset:6144
    ds_write_b128 v7, v[44:47] offset:7168
    ds_write_b128 v7, v[48:51] offset:8192
    ds_write_b128 v7, v[52:55] offset:9216
    ds_write_b128 v7, v[56:59] offset:10240
    ds_write_b128 v7, v[60:63] offset:11264
    ds_write_b128 v7, v[64:67] offset:12288
    ds_write_b128 v7, v[68:71] offset:13312
    ds_write_b128 v7, v[72:75] offset:14336
    ds_write_b128 v7, v[76:79] offset:15360
m_r1_13:
    s_waitcnt lgkmcnt(0)
    s_barrier
    s_cmp_ge_u32 s3, 4
    s_cbranch_scc1 m_r2_14
    ds_read_b128 v[80:83], v7 offset:0
    ds_read_b128 v[84:87], v7 offset:1024
    ds_read_b128 v[88:91], v7 offset:2048
    ds_read_b128 v[92:95], v7 offset:3072
    ds_read_b128 v[96:99], v7 offset:4096
    ds_read_b128 v[100:103], v7 offset:5120
    ds_read_b128 v[104:107], v7 offset:6144
    ds_read_b128 v[108:111], v7 offset:7168
    s_waitcnt lgkmcnt(0)
    v_pk_add_f32 v[16:17], v[16:17], v[80:81]
    v_pk_add_f32 v[18:19], v[18:19], v[82:83]
    v_pk_add_f32 v[20:21], v[20:21], v[84:85]
    v_pk_add_f32 v[22:23], v[22:23], v[86:87]
    v_pk_add_f32 v[24:25], v[24:25], v[88:89]
    v_pk_add_f32 v[26:27], v[26:27], v[90:91]
    v_pk_add_f32 v[28:29], v[28:29], v[92:93]
    v_pk_add_f32 v[30:31], v[30:31], v[94:95]
    v_pk_add_f32 v[32:33], v[32:33], v[96:97]
    v_pk_add_f32 v[34:35], v[34:35], v[98:99]
    v_pk_add_f32 v[36:37], v[36:37], v[100:101]
    v_pk_add_f32 v[38:39], v[38:39], v[102:103]
    v_pk_add_f32 v[40:41], v[40:41], v[104:105]
    v_pk_add_f32 v[42:43], v[42:43], v[106:107]
    v_pk_add_f32 v[44:45], v[44:45], v[108:109]
    v_pk_add_f32 v[46:47], v[46:47], v[110:111]
    ds_read_b128 v[80:83], v7 offset:8192
    ds_read_b128 v[84:87], v7 offset:9216
    ds_read_b128 v[88:91], v7 offset:10240
    ds_read_b128 v[92:95], v7 offset:11264
    ds_read_b128 v[96:99], v7 offset:12288
    ds_read_b128 v[100:103], v7 offset:13312
    ds_read_b128 v[104:107], v7 offset:14336
    ds_read_b128 v[108:111], v7 offset:15360
    s_waitcnt lgkmcnt(0)
    v_pk_add_f32 v[48:49], v[48:49], v[80:81]
    v_pk_add_f32 v[50:51], v[50:51], v[82:83]
    v_pk_add_f32 v[52:53], v[52:53], v[84:85]
    v_pk_add_f32 v[54:55], v[54:55], v[86:87]
    v_pk_add_f32 v[56:57], v[56:57], v[88:89]
    v_pk_add_f32 v[58:59], v[58:59], v[90:91]
    v_pk_add_f32 v[60:61], v[60:61], v[92:93]
    v_pk_add_f32 v[62:63], v[62:63], v[94:95]
    v_pk_add_f32 v[64:65], v[64:65], v[96:97]
    v_pk_add_f32 v[66:67], v[66:67], v[98:99]
    v_pk_add_f32 v[68:69], v[68:69], v[100:101]
    v_pk_add_f32 v[70:71], v[70:71], v[102:103]
    v_pk_add_f32 v[72:73], v[72:73], v[104:105]
    v_pk_add_f32 v[74:75], v[74:75], v[106:107]
    v_pk_add_f32 v[76:77], v[76:77], v[108:109]
    v_pk_add_f32 v[78:79], v[78:79], v[110:111]
    ds_write_b128 v7, v[16:19] offset:0
    ds_write_b128 v7, v[20:23] offset:1024
    ds_write_b128 v7, v[24:27] offset:2048
    ds_write_b128 v7, v[28:31] offset:3072
    ds_write_b128 v7, v[32:35] offset:4096
    ds_write_b128 v7, v[36:39] offset:5120
    ds_write_b128 v7, v[40:43] offset:6144
    ds_write_b128 v7, v[44:47] offset:7168
    ds_write_b128 v7, v[48:51] offset:8192
    ds_write_b128 v7, v[52:55] offset:9216
    ds_write_b128 v7, v[56:59] offset:10240
    ds_write_b128 v7, v[60:63] offset:11264
    ds_write_b128 v7, v[64:67] offset:12288
    ds_write_b128 v7, v[68:71] offset:13312
    ds_write_b128 v7, v[72:75] offset:14336
    ds_write_b128 v7, v[76:79] offset:15360
m_r2_14:
    s_waitcnt lgkmcnt(0)
    s_barrier
    s_lshr_b32 s50, s3, 1
    s_lshl_b32 s50, s50, 12
    s_and_b32 s53, s3, 1
    s_lshl_b32 s53, s53, 11
    s_add_u32 s50, s50, s53
    v_add_u32 v7, s50, v6
    ds_read_b128 v[16:19], v7 offset:0
    ds_read_b128 v[20:23], v7 offset:1024
    ds_read_b128 v[24:27], v7 offset:16384
    ds_read_b128 v[28:31], v7 offset:17408
    ds_read_b128 v[32:35], v7 offset:32768
    ds_read_b128 v[36:39], v7 offset:33792
    ds_read_b128 v[40:43], v7 offset:49152
    ds_read_b128 v[44:47], v7 offset:50176
    v_lshlrev_b32 v80, 16, v120
    v_and_b32 v81, 0xffff0000, v120
    v_lshlrev_b32 v82, 16, v121
    v_and_b32 v83, 0xffff0000, v121
    v_lshlrev_b32 v84, 16, v122
    v_and_b32 v85, 0xffff0000, v122
    v_lshlrev_b32 v86, 16, v123
    v_and_b32 v87, 0xffff0000, v123
    s_waitcnt lgkmcnt(0)
    s_barrier
    s_lshl_b32 s41, s3, 16
    s_lshl_b32 s44, s3, 13
    s_add_u32 m0, s44, 0
    s_add_u32 s46, s41, 0
    buffer_load_dwordx4 v9, s[32:35], s46 offen lds
    s_add_u32 m0, s44, 1024
    s_add_u32 s46, s41, 8192
    buffer_load_dwordx4 v9, s[32:35], s46 offen lds
    s_add_u32 m0, s44, 2048
    s_add_u32 s46, s41, 16384
    buffer_load_dwordx4 v9, s[32:35], s46 offen lds
    s_add_u32 m0, s44, 3072
    s_add_u32 s46, s41, 24576
    buffer_load_dwordx4 v9, s[32:35], s46 offen lds
    s_add_u32 m0, s44, 4096
    s_add_u32 s46, s41, 32768
    buffer_load_dwordx4 v9, s[32:35], s46 offen lds
    s_add_u32 m0, s44, 5120
    s_add_u32 s46, s41, 40960
    buffer_load_dwordx4 v9, s[32:35], s46 offen lds
    s_add_u32 m0, s44, 6144
    s_add_u32 s46, s41, 49152
    buffer_load_dwordx4 v9, s[32:35], s46 offen lds
    s_add_u32 m0, s44, 7168
    s_add_u32 s46, s41, 57344
    buffer_load_dwordx4 v9, s[32:35], s46 offen lds
    v_pk_add_f32 v[16:17], v[16:17], v[24:25]
    v_pk_add_f32 v[32:33], v[32:33], v[40:41]
    v_pk_add_f32 v[18:19], v[18:19], v[26:27]
    v_pk_add_f32 v[34:35], v[34:35], v[42:43]
    v_pk_add_f32 v[20:21], v[20:21], v[28:29]
    v_pk_add_f32 v[36:37], v[36:37], v[44:45]
    v_pk_add_f32 v[22:23], v[22:23], v[30:31]
    v_pk_add_f32 v[38:39], v[38:39], v[46:47]
    v_pk_add_f32 v[16:17], v[16:17], v[80:81]
    v_pk_add_f32 v[18:19], v[18:19], v[82:83]
    v_pk_add_f32 v[20:21], v[20:21], v[84:85]
    v_pk_add_f32 v[22:23], v[22:23], v[86:87]
    v_pk_add_f32 v[16:17], v[16:17], v[32:33]
    v_pk_add_f32 v[18:19], v[18:19], v[34:35]
    v_pk_add_f32 v[20:21], v[20:21], v[36:37]
    v_pk_add_f32 v[22:23], v[22:23], v[38:39]
    s_lshr_b32 s47, s3, 2
    s_bfe_u32 s48, s3, 0x10001
    s_and_b32 s50, s3, 1
    v_bfe_u32 v10, v1, 2, 2
    v_lshl_add_u32 v11, v3, 2, v10
    v_lshlrev_b32 v11, 7, v11
    v_bfe_u32 v12, v1, 4, 1
    v_lshl_add_u32 v11, v12, 5, v11
    v_and_b32 v12, 3, v1
    v_lshl_add_u32 v11, v12, 3, v11
    v_lshrrev_b32 v10, 1, v10
    v_xor_b32 v10, s47, v10
    v_lshl_add_u32 v11, v10, 6, v11
    s_lshl_b32 s53, s50, 15
    v_add_u32 v11, s53, v11
    s_mul_i32 s42, s48, 147456
    s_add_u32 s42, s42, s43
    s_lshl_b32 s53, s50, 14
    s_add_u32 s42, s42, s53
    s_waitcnt vmcnt(0)
    s_barrier
    ds_read_b64_tr_b16 v[40:41], v11 offset:0
    ds_read_b64_tr_b16 v[42:43], v11 offset:1024
    ds_read_b64_tr_b16 v[44:45], v11 offset:2048
    ds_read_b64_tr_b16 v[46:47], v11 offset:3072
    ds_read_b64_tr_b16 v[48:49], v11 offset:4096
    ds_read_b64_tr_b16 v[50:51], v11 offset:5120
    ds_read_b64_tr_b16 v[52:53], v11 offset:6144
    ds_read_b64_tr_b16 v[54:55], v11 offset:7168
    ds_read_b64_tr_b16 v[56:57], v11 offset:8192
    ds_read_b64_tr_b16 v[58:59], v11 offset:9216
    ds_read_b64_tr_b16 v[60:61], v11 offset:10240
    ds_read_b64_tr_b16 v[62:63], v11 offset:11264
    ds_read_b64_tr_b16 v[64:65], v11 offset:12288
    ds_read_b64_tr_b16 v[66:67], v11 offset:13312
    ds_read_b64_tr_b16 v[68:69], v11 offset:14336
    ds_read_b64_tr_b16 v[70:71], v11 offset:15360
    ds_read_b64_tr_b16 v[72:73], v11 offset:16384
    ds_read_b64_tr_b16 v[74:75], v11 offset:17408
    ds_read_b64_tr_b16 v[76:77], v11 offset:18432
    ds_read_b64_tr_b16 v[78:79], v11 offset:19456
    ds_read_b64_tr_b16 v[80:81], v11 offset:20480
    ds_read_b64_tr_b16 v[82:83], v11 offset:21504
    ds_read_b64_tr_b16 v[84:85], v11 offset:22528
    ds_read_b64_tr_b16 v[86:87], v11 offset:23552
    ds_read_b64_tr_b16 v[88:89], v11 offset:24576
    ds_read_b64_tr_b16 v[90:91], v11 offset:25600
    ds_read_b64_tr_b16 v[92:93], v11 offset:26624
    ds_read_b64_tr_b16 v[94:95], v11 offset:27648
    ds_read_b64_tr_b16 v[96:97], v11 offset:28672
    ds_read_b64_tr_b16 v[98:99], v11 offset:29696
    ds_read_b64_tr_b16 v[100:101], v11 offset:30720
    ds_read_b64_tr_b16 v[102:103], v11 offset:31744
    s_lshl_b32 s49, s37, 7
    s_add_u32 s49, s49, 3153920
    s_waitcnt lgkmcnt(0)
    s_cmp_lg_u32 s3, 0
    s_cbranch_scc1 m_polled_16
    v_lshlrev_b32 v4, 3, v1
    v_add_u32 v4, s49, v4
    s_mov_b64 s[46:47], exec
    s_mov_b32 exec_lo, 0xff
    s_mov_b32 exec_hi, 0x0
m_poll_15:
    global_load_dwordx2 v[124:125], v4, s[12:13] sc1
    s_waitcnt vmcnt(0)
    v_cmp_ne_u64 vcc, s[68:69], v[124:125]
    s_cmp_eq_u64 vcc, 0
    s_cbranch_scc1 m_poll_15_ok
    s_sleep 2
    s_branch m_poll_15
m_poll_15_ok:
    s_mov_b64 exec, s[46:47]
m_polled_16:
    s_barrier
    s_add_u32 s46, s42, 0
    buffer_load_dwordx4 v[104:107], v6, s[28:31], s46 offen offset:0
    s_add_u32 s46, s42, 0
    buffer_load_dwordx4 v[108:111], v6, s[28:31], s46 offen offset:1024
    s_add_u32 s46, s42, 0
    buffer_load_dwordx4 v[112:115], v6, s[28:31], s46 offen offset:2048
    s_add_u32 s46, s42, 0
    buffer_load_dwordx4 v[116:119], v6, s[28:31], s46 offen offset:3072
    s_add_u32 s46, s42, 4096
    buffer_load_dwordx4 v[120:123], v6, s[28:31], s46 offen offset:0
    s_add_u32 s46, s42, 4096
    buffer_load_dwordx4 v[124:127], v6, s[28:31], s46 offen offset:1024
    s_waitcnt vmcnt(5)
    v_mfma_f32_32x32x16_bf16 v[24:39], v[40:43], v[104:107], 0
    s_add_u32 s46, s42, 4096
    buffer_load_dwordx4 v[104:107], v6, s[28:31], s46 offen offset:2048
    s_waitcnt vmcnt(5)
    v_mfma_f32_32x32x16_bf16 v[24:39], v[44:47], v[108:111], v[24:39]
    s_add_u32 s46, s42, 4096
    buffer_load_dwordx4 v[108:111], v6, s[28:31], s46 offen offset:3072
    s_waitcnt vmcnt(5)
    v_mfma_f32_32x32x16_bf16 v[24:39], v[48:51], v[112:115], v[24:39]
    s_add_u32 s46, s42, 8192
    buffer_load_dwordx4 v[112:115], v6, s[28:31], s46 offen offset:0
    s_waitcnt vmcnt(5)
    v_mfma_f32_32x32x16_bf16 v[24:39], v[52:55], v[116:119], v[24:39]
    s_add_u32 s46, s42, 8192
    buffer_load_dwordx4 v[116:119], v6, s[28:31], s46 offen offset:1024
    s_waitcnt vmcnt(5)
    v_mfma_f32_32x32x16_bf16 v[24:39], v[56:59], v[120:123], v[24:39]
    s_add_u32 s46, s42, 8192
    buffer_load_dwordx4 v[120:123], v6, s[28:31], s46 offen offset:2048
    s_waitcnt vmcnt(5)
    v_mfma_f32_32x32x16_bf16 v[24:39], v[60:63], v[124:127], v[24:39]
    s_add_u32 s46, s42, 8192
    buffer_load_dwordx4 v[124:127], v6, s[28:31], s46 offen offset:3072
    s_waitcnt vmcnt(5)
    v_mfma_f32_32x32x16_bf16 v[24:39], v[64:67], v[104:107], v[24:39]
    s_add_u32 s46, s42, 12288
    buffer_load_dwordx4 v[104:107], v6, s[28:31], s46 offen offset:0
    s_waitcnt vmcnt(5)
    v_mfma_f32_32x32x16_bf16 v[24:39], v[68:71], v[108:111], v[24:39]
    s_add_u32 s46, s42, 12288
    buffer_load_dwordx4 v[108:111], v6, s[28:31], s46 offen offset:1024
    s_waitcnt vmcnt(5)
    v_mfma_f32_32x32x16_bf16 v[24:39], v[72:75], v[112:115], v[24:39]
    s_add_u32 s46, s42, 12288
    buffer_load_dwordx4 v[112:115], v6, s[28:31], s46 offen offset:2048
    s_waitcnt vmcnt(5)
    v_mfma_f32_32x32x16_bf16 v[24:39], v[76:79], v[116:119], v[24:39]
    s_add_u32 s46, s42, 12288
    buffer_load_dwordx4 v[116:119], v6, s[28:31], s46 offen offset:3072
    s_waitcnt vmcnt(5)
    v_mfma_f32_32x32x16_bf16 v[24:39], v[80:83], v[120:123], v[24:39]
    s_waitcnt vmcnt(4)
    v_mfma_f32_32x32x16_bf16 v[24:39], v[84:87], v[124:127], v[24:39]
    s_waitcnt vmcnt(3)
    v_mfma_f32_32x32x16_bf16 v[24:39], v[88:91], v[104:107], v[24:39]
    s_waitcnt vmcnt(2)
    v_mfma_f32_32x32x16_bf16 v[24:39], v[92:95], v[108:111], v[24:39]
    s_waitcnt vmcnt(1)
    v_mfma_f32_32x32x16_bf16 v[24:39], v[96:99], v[112:115], v[24:39]
    s_waitcnt vmcnt(0)
    v_mfma_f32_32x32x16_bf16 v[24:39], v[100:103], v[116:119], v[24:39]
    s_lshl_b32 s41, s3, 11
    v_add_u32 v7, s41, v6
    s_xor_b32 s41, s41, 2048
    v_add_u32 v4, s41, v6
    s_nop 7
    s_nop 3
    s_cmp_eq_u32 s50, 0
    s_cbranch_scc1 m_nosw2
    v_swap_b32 v24, v32
    v_swap_b32 v25, v33
    v_swap_b32 v26, v34
    v_swap_b32 v27, v35
    v_swap_b32 v28, v36
    v_swap_b32 v29, v37
    v_swap_b32 v30, v38
    v_swap_b32 v31, v39
m_nosw2:
    ds_write_b128 v7, v[32:35]
    ds_write_b128 v7, v[36:39] offset:1024
    v_pk_add_f32 v[16:17], v[16:17], v[24:25]
    v_pk_add_f32 v[18:19], v[18:19], v[26:27]
    v_pk_add_f32 v[20:21], v[20:21], v[28:29]
    v_pk_add_f32 v[22:23], v[22:23], v[30:31]
    s_waitcnt lgkmcnt(0)
    s_barrier
    ds_read_b128 v[40:43], v4
    ds_read_b128 v[44:47], v4 offset:1024
    s_waitcnt lgkmcnt(0)
    v_pk_add_f32 v[16:17], v[16:17], v[40:41]
    v_pk_add_f32 v[18:19], v[18:19], v[42:43]
    v_pk_add_f32 v[20:21], v[20:21], v[44:45]
    v_pk_add_f32 v[22:23], v[22:23], v[46:47]
    v_cvt_pk_bf16_f32 v96, v16, v17
    v_cvt_pk_bf16_f32 v97, v18, v19
    v_cvt_pk_bf16_f32 v98, v20, v21
    v_cvt_pk_bf16_f32 v99, v22, v23
    s_nop 1
    v_permlane32_swap_b32 v96, v98
    v_permlane32_swap_b32 v97, v99
    v_lshl_add_u32 v15, v3, 4, v14
    buffer_store_dwordx4 v[96:99], v15, s[20:23], 0 offen
    s_endpgm
m_att:
    s_setprio 1
    s_lshr_b32 s36, s2, 5
    buffer_load_dwordx4 v[24:27], v7, s[16:19], s38 offen offset:0
    buffer_load_dwordx4 v[28:31], v7, s[16:19], s38 offen offset:128
    buffer_load_dwordx4 v[32:35], v7, s[16:19], s38 offen offset:256
    buffer_load_dwordx4 v[36:39], v7, s[16:19], s38 offen offset:384
    s_and_b32 s38, s3, 1
    s_bfe_u32 s39, s3, 0x10001
    s_lshr_b32 s40, s3, 2
    s_mov_b32 s20, s6
    s_and_b32 s21, s7, 0xffff
    s_mov_b32 s22, 524288
    s_mov_b32 s23, 0x00020000
    v_bfe_u32 v40, v1, 2, 1
    v_bfe_u32 v41, v1, 4, 1
    v_xor_b32 v40, v40, v41
    v_lshlrev_b32 v127, 6, v40
    v_and_b32 v40, 3, v1
    v_lshl_add_u32 v127, v40, 4, v127
    v_lshl_add_u32 v127, v4, 10, v127
    s_lshl_b32 s41, s36, 7
    v_add_u32 v127, s41, v127
    s_lshl_b32 s42, s3, 16
    s_lshl_b32 s43, s3, 13
    v_bfe_u32 v40, v1, 2, 2
    v_lshl_add_u32 v122, v3, 3, v40
    v_lshlrev_b32 v122, 7, v122
    v_lshrrev_b32 v40, 1, v40
    v_xor_b32 v40, s39, v40
    v_lshl_add_u32 v122, v40, 6, v122
    v_bfe_u32 v40, v1, 4, 1
    v_lshl_add_u32 v122, v40, 5, v122
    v_and_b32 v40, 3, v1
    v_lshl_add_u32 v122, v40, 3, v122
    s_lshl_b32 s41, s40, 15
    v_add_u32 v122, s41, v122
    v_mov_b32 v104, 0x3f803f80
    v_mov_b32 v105, 0
    v_mov_b32 v106, 0
    s_add_u32 m0, s43, 0
    s_add_u32 s41, s42, 0
    buffer_load_dwordx4 v127, s[20:23], s41 offen lds
    s_add_u32 m0, s43, 1024
    s_add_u32 s41, s42, 8192
    buffer_load_dwordx4 v127, s[20:23], s41 offen lds
    s_add_u32 m0, s43, 2048
    s_add_u32 s41, s42, 16384
    buffer_load_dwordx4 v127, s[20:23], s41 offen lds
    s_add_u32 m0, s43, 3072
    s_add_u32 s41, s42, 24576
    buffer_load_dwordx4 v127, s[20:23], s41 offen lds
    s_add_u32 m0, s43, 4096
    s_add_u32 s41, s42, 32768
    buffer_load_dwordx4 v127, s[20:23], s41 offen lds
    s_add_u32 m0, s43, 5120
    s_add_u32 s41, s42, 40960
    buffer_load_dwordx4 v127, s[20:23], s41 offen lds
    s_add_u32 m0, s43, 6144
    s_add_u32 s41, s42, 49152
    buffer_load_dwordx4 v127, s[20:23], s41 offen lds
    s_add_u32 m0, s43, 7168
    s_add_u32 s41, s42, 57344
    buffer_load_dwordx4 v127, s[20:23], s41 offen lds
    s_waitcnt vmcnt(8)
    s_cmp_lg_u32 s3, 0
    s_cbranch_scc1 m_eed_17
    v_mov_b32 v126, 0
    global_load_dwordx2 v[124:125], v126, s[14:15] sc1
m_eed_17:
    v_dot2c_f32_bf16 v105, v8, v104
    v_dot2c_f32_bf16 v106, v9, v104
    v_dot2c_f32_bf16 v105, v10, v104
    v_dot2c_f32_bf16 v106, v11, v104
    v_dot2c_f32_bf16 v105, v12, v104
    v_dot2c_f32_bf16 v106, v13, v104
    v_dot2c_f32_bf16 v105, v14, v104
    v_dot2c_f32_bf16 v106, v15, v104
    v_dot2c_f32_bf16 v105, v16, v104
    v_dot2c_f32_bf16 v106, v17, v104
    v_dot2c_f32_bf16 v105, v18, v104
    v_dot2c_f32_bf16 v106, v19, v104
    v_dot2c_f32_bf16 v105, v20, v104
    v_dot2c_f32_bf16 v106, v21, v104
    v_dot2c_f32_bf16 v105, v22, v104
    v_dot2c_f32_bf16 v106, v23, v104
    v_dot2c_f32_bf16 v105, v24, v104
    v_dot2c_f32_bf16 v106, v25, v104
    v_dot2c_f32_bf16 v105, v26, v104
    v_dot2c_f32_bf16 v106, v27, v104
    v_dot2c_f32_bf16 v105, v28, v104
    v_dot2c_f32_bf16 v106, v29, v104
    v_dot2c_f32_bf16 v105, v30, v104
    v_dot2c_f32_bf16 v106, v31, v104
    v_dot2c_f32_bf16 v105, v32, v104
    v_dot2c_f32_bf16 v106, v33, v104
    v_dot2c_f32_bf16 v105, v34, v104
    v_dot2c_f32_bf16 v106, v35, v104
    v_dot2c_f32_bf16 v105, v36, v104
    v_dot2c_f32_bf16 v106, v37, v104
    v_dot2c_f32_bf16 v105, v38, v104
    v_dot2c_f32_bf16 v106, v39, v104
    v_lshlrev_b32 v40, 16, v8
    v_and_b32 v41, 0xffff0000, v8
    v_lshlrev_b32 v42, 16, v9
    v_and_b32 v43, 0xffff0000, v9
    v_lshlrev_b32 v44, 16, v10
    v_and_b32 v45, 0xffff0000, v10
    v_lshlrev_b32 v46, 16, v11
    v_and_b32 v47, 0xffff0000, v11
    v_lshlrev_b32 v48, 16, v12
    v_and_b32 v49, 0xffff0000, v12
    v_lshlrev_b32 v50, 16, v13
    v_and_b32 v51, 0xffff0000, v13
    v_lshlrev_b32 v52, 16, v14
    v_and_b32 v53, 0xffff0000, v14
    v_lshlrev_b32 v54, 16, v15
    v_and_b32 v55, 0xffff0000, v15
    v_lshlrev_b32 v56, 16, v16
    v_and_b32 v57, 0xffff0000, v16
    v_lshlrev_b32 v58, 16, v17
    v_and_b32 v59, 0xffff0000, v17
    v_lshlrev_b32 v60, 16, v18
    v_and_b32 v61, 0xffff0000, v18
    v_lshlrev_b32 v62, 16, v19
    v_and_b32 v63, 0xffff0000, v19
    v_lshlrev_b32 v64, 16, v20
    v_and_b32 v65, 0xffff0000, v20
    v_lshlrev_b32 v66, 16, v21
    v_and_b32 v67, 0xffff0000, v21
    v_lshlrev_b32 v68, 16, v22
    v_and_b32 v69, 0xffff0000, v22
    v_lshlrev_b32 v70, 16, v23
    v_and_b32 v71, 0xffff0000, v23
    v_lshlrev_b32 v72, 16, v24
    v_and_b32 v73, 0xffff0000, v24
    v_lshlrev_b32 v74, 16, v25
    v_and_b32 v75, 0xffff0000, v25
    v_lshlrev_b32 v76, 16, v26
    v_and_b32 v77, 0xffff0000, v26
    v_lshlrev_b32 v78, 16, v27
    v_and_b32 v79, 0xffff0000, v27
    v_lshlrev_b32 v80, 16, v28
    v_and_b32 v81, 0xffff0000, v28
    v_lshlrev_b32 v82, 16, v29
    v_and_b32 v83, 0xffff0000, v29
    v_lshlrev_b32 v84, 16, v30
    v_and_b32 v85, 0xffff0000, v30
    v_lshlrev_b32 v86, 16, v31
    v_and_b32 v87, 0xffff0000, v31
    v_lshlrev_b32 v88, 16, v32
    v_and_b32 v89, 0xffff0000, v32
    v_lshlrev_b32 v90, 16, v33
    v_and_b32 v91, 0xffff0000, v33
    v_lshlrev_b32 v92, 16, v34
    v_and_b32 v93, 0xffff0000, v34
    v_lshlrev_b32 v94, 16, v35
    v_and_b32 v95, 0xffff0000, v35
    v_lshlrev_b32 v96, 16, v36
    v_and_b32 v97, 0xffff0000, v36
    v_lshlrev_b32 v98, 16, v37
    v_and_b32 v99, 0xffff0000, v37
    v_lshlrev_b32 v100, 16, v38
    v_and_b32 v101, 0xffff0000, v38
    v_lshlrev_b32 v102, 16, v39
    v_and_b32 v103, 0xffff0000, v39
    v_add_f32 v105, v105, v106
    s_nop 1
    v_add_f32_dpp v105, v105, v105 quad_perm:[1,0,3,2] row_mask:0xf bank_mask:0xf
    s_nop 1
    v_add_f32_dpp v105, v105, v105 quad_perm:[2,3,0,1] row_mask:0xf bank_mask:0xf
    s_nop 1
    v_add_f32_dpp v105, v105, v105 row_half_mirror row_mask:0xf bank_mask:0xf
    v_mul_f32 v107, 0x3b000000, v105
    v_cvt_pk_bf16_f32 v108, v107, v107
    v_lshlrev_b32 v108, 16, v108
    v_sub_f32 v110, 0, v108
    v_sub_f32 v107, v107, v108
    v_mov_b32 v112, 0
    v_mov_b32 v113, 0
    v_pk_add_f32 v[40:41], v[40:41], v[110:111] op_sel_hi:[1,0]
    v_pk_add_f32 v[42:43], v[42:43], v[110:111] op_sel_hi:[1,0]
    v_pk_add_f32 v[44:45], v[44:45], v[110:111] op_sel_hi:[1,0]
    v_pk_add_f32 v[46:47], v[46:47], v[110:111] op_sel_hi:[1,0]
    v_pk_add_f32 v[48:49], v[48:49], v[110:111] op_sel_hi:[1,0]
    v_pk_add_f32 v[50:51], v[50:51], v[110:111] op_sel_hi:[1,0]
    v_pk_add_f32 v[52:53], v[52:53], v[110:111] op_sel_hi:[1,0]
    v_pk_add_f32 v[54:55], v[54:55], v[110:111] op_sel_hi:[1,0]
    v_pk_add_f32 v[56:57], v[56:57], v[110:111] op_sel_hi:[1,0]
    v_pk_add_f32 v[58:59], v[58:59], v[110:111] op_sel_hi:[1,0]
    v_pk_add_f32 v[60:61], v[60:61], v[110:111] op_sel_hi:[1,0]
    v_pk_add_f32 v[62:63], v[62:63], v[110:111] op_sel_hi:[1,0]
    v_pk_add_f32 v[64:65], v[64:65], v[110:111] op_sel_hi:[1,0]
    v_pk_add_f32 v[66:67], v[66:67], v[110:111] op_sel_hi:[1,0]
    v_pk_add_f32 v[68:69], v[68:69], v[110:111] op_sel_hi:[1,0]
    v_pk_add_f32 v[70:71], v[70:71], v[110:111] op_sel_hi:[1,0]
    v_pk_add_f32 v[72:73], v[72:73], v[110:111] op_sel_hi:[1,0]
    v_pk_add_f32 v[74:75], v[74:75], v[110:111] op_sel_hi:[1,0]
    v_pk_add_f32 v[76:77], v[76:77], v[110:111] op_sel_hi:[1,0]
    v_pk_add_f32 v[78:79], v[78:79], v[110:111] op_sel_hi:[1,0]
    v_pk_add_f32 v[80:81], v[80:81], v[110:111] op_sel_hi:[1,0]
    v_pk_add_f32 v[82:83], v[82:83], v[110:111] op_sel_hi:[1,0]
    v_pk_add_f32 v[84:85], v[84:85], v[110:111] op_sel_hi:[1,0]
    v_pk_add_f32 v[86:87], v[86:87], v[110:111] op_sel_hi:[1,0]
    v_pk_add_f32 v[88:89], v[88:89], v[110:111] op_sel_hi:[1,0]
    v_pk_add_f32 v[90:91], v[90:91], v[110:111] op_sel_hi:[1,0]
    v_pk_add_f32 v[92:93], v[92:93], v[110:111] op_sel_hi:[1,0]
    v_pk_add_f32 v[94:95], v[94:95], v[110:111] op_sel_hi:[1,0]
    v_pk_add_f32 v[96:97], v[96:97], v[110:111] op_sel_hi:[1,0]
    v_pk_add_f32 v[98:99], v[98:99], v[110:111] op_sel_hi:[1,0]
    v_pk_add_f32 v[100:101], v[100:101], v[110:111] op_sel_hi:[1,0]
    v_pk_add_f32 v[102:103], v[102:103], v[110:111] op_sel_hi:[1,0]
    v_pk_fma_f32 v[112:113], v[40:41], v[40:41], v[112:113]
    v_pk_fma_f32 v[112:113], v[42:43], v[42:43], v[112:113]
    v_pk_fma_f32 v[112:113], v[44:45], v[44:45], v[112:113]
    v_pk_fma_f32 v[112:113], v[46:47], v[46:47], v[112:113]
    v_pk_fma_f32 v[112:113], v[48:49], v[48:49], v[112:113]
    v_pk_fma_f32 v[112:113], v[50:51], v[50:51], v[112:113]
    v_pk_fma_f32 v[112:113], v[52:53], v[52:53], v[112:113]
    v_pk_fma_f32 v[112:113], v[54:55], v[54:55], v[112:113]
    v_pk_fma_f32 v[112:113], v[56:57], v[56:57], v[112:113]
    v_pk_fma_f32 v[112:113], v[58:59], v[58:59], v[112:113]
    v_pk_fma_f32 v[112:113], v[60:61], v[60:61], v[112:113]
    v_pk_fma_f32 v[112:113], v[62:63], v[62:63], v[112:113]
    v_pk_fma_f32 v[112:113], v[64:65], v[64:65], v[112:113]
    v_pk_fma_f32 v[112:113], v[66:67], v[66:67], v[112:113]
    v_pk_fma_f32 v[112:113], v[68:69], v[68:69], v[112:113]
    v_pk_fma_f32 v[112:113], v[70:71], v[70:71], v[112:113]
    v_pk_fma_f32 v[112:113], v[72:73], v[72:73], v[112:113]
    v_pk_fma_f32 v[112:113], v[74:75], v[74:75], v[112:113]
    v_pk_fma_f32 v[112:113], v[76:77], v[76:77], v[112:113]
    v_pk_fma_f32 v[112:113], v[78:79], v[78:79], v[112:113]
    v_pk_fma_f32 v[112:113], v[80:81], v[80:81], v[112:113]
    v_pk_fma_f32 v[112:113], v[82:83], v[82:83], v[112:113]
    v_pk_fma_f32 v[112:113], v[84:85], v[84:85], v[112:113]
    v_pk_fma_f32 v[112:113], v[86:87], v[86:87], v[112:113]
    v_pk_fma_f32 v[112:113], v[88:89], v[88:89], v[112:113]
    v_pk_fma_f32 v[112:113], v[90:91], v[90:91], v[112:113]
    v_pk_fma_f32 v[112:113], v[92:93], v[92:93], v[112:113]
    v_pk_fma_f32 v[112:113], v[94:95], v[94:95], v[112:113]
    v_pk_fma_f32 v[112:113], v[96:97], v[96:97], v[112:113]
    v_pk_fma_f32 v[112:113], v[98:99], v[98:99], v[112:113]
    v_pk_fma_f32 v[112:113], v[100:101], v[100:101], v[112:113]
    v_pk_fma_f32 v[112:113], v[102:103], v[102:103], v[112:113]
    v_add_f32 v112, v112, v113
    s_nop 1
    v_add_f32_dpp v112, v112, v112 quad_perm:[1,0,3,2] row_mask:0xf bank_mask:0xf
    s_nop 1
    v_add_f32_dpp v112, v112, v112 quad_perm:[2,3,0,1] row_mask:0xf bank_mask:0xf
    s_nop 1
    v_add_f32_dpp v112, v112, v112 row_half_mirror row_mask:0xf bank_mask:0xf
    v_mul_f32 v112, 0x3b000000, v112
    v_fma_f32 v112, -v107, v107, v112
    v_max_f32 v112, 0, v112
    v_cvt_pk_bf16_f32 v112, v112, v112
    v_lshlrev_b32 v112, 16, v112
    v_add_f32 v112, 0x3727c5ac, v112
    v_cvt_pk_bf16_f32 v112, v112, v112
    v_lshlrev_b32 v112, 16, v112
    v_sqrt_f32 v112, v112
    s_nop 0
    v_cvt_pk_bf16_f32 v112, v112, v112
    v_lshlrev_b32 v112, 16, v112
    v_rcp_f32 v110, v112
    v_cvt_pk_bf16_f32 v8, v40, v41
    v_cvt_pk_bf16_f32 v9, v42, v43
    v_cvt_pk_bf16_f32 v10, v44, v45
    v_cvt_pk_bf16_f32 v11, v46, v47
    v_cvt_pk_bf16_f32 v12, v48, v49
    v_cvt_pk_bf16_f32 v13, v50, v51
    v_cvt_pk_bf16_f32 v14, v52, v53
    v_cvt_pk_bf16_f32 v15, v54, v55
    v_cvt_pk_bf16_f32 v16, v56, v57
    v_cvt_pk_bf16_f32 v17, v58, v59
    v_cvt_pk_bf16_f32 v18, v60, v61
    v_cvt_pk_bf16_f32 v19, v62, v63
    v_cvt_pk_bf16_f32 v20, v64, v65
    v_cvt_pk_bf16_f32 v21, v66, v67
    v_cvt_pk_bf16_f32 v22, v68, v69
    v_cvt_pk_bf16_f32 v23, v70, v71
    v_cvt_pk_bf16_f32 v24, v72, v73
    v_cvt_pk_bf16_f32 v25, v74, v75
    v_cvt_pk_bf16_f32 v26, v76, v77
    v_cvt_pk_bf16_f32 v27, v78, v79
    v_cvt_pk_bf16_f32 v28, v80, v81
    v_cvt_pk_bf16_f32 v29, v82, v83
    v_cvt_pk_bf16_f32 v30, v84, v85
    v_cvt_pk_bf16_f32 v31, v86, v87
    v_cvt_pk_bf16_f32 v32, v88, v89
    v_cvt_pk_bf16_f32 v33, v90, v91
    v_cvt_pk_bf16_f32 v34, v92, v93
    v_cvt_pk_bf16_f32 v35, v94, v95
    v_cvt_pk_bf16_f32 v36, v96, v97
    v_cvt_pk_bf16_f32 v37, v98, v99
    v_cvt_pk_bf16_f32 v38, v100, v101
    v_cvt_pk_bf16_f32 v39, v102, v103
    v_lshlrev_b32 v40, 16, v8
    v_and_b32 v41, 0xffff0000, v8
    v_lshlrev_b32 v42, 16, v9
    v_and_b32 v43, 0xffff0000, v9
    v_lshlrev_b32 v44, 16, v10
    v_and_b32 v45, 0xffff0000, v10
    v_lshlrev_b32 v46, 16, v11
    v_and_b32 v47, 0xffff0000, v11
    v_lshlrev_b32 v48, 16, v12
    v_and_b32 v49, 0xffff0000, v12
    v_lshlrev_b32 v50, 16, v13
    v_and_b32 v51, 0xffff0000, v13
    v_lshlrev_b32 v52, 16, v14
    v_and_b32 v53, 0xffff0000, v14
    v_lshlrev_b32 v54, 16, v15
    v_and_b32 v55, 0xffff0000, v15
    v_lshlrev_b32 v56, 16, v16
    v_and_b32 v57, 0xffff0000, v16
    v_lshlrev_b32 v58, 16, v17
    v_and_b32 v59, 0xffff0000, v17
    v_lshlrev_b32 v60, 16, v18
    v_and_b32 v61, 0xffff0000, v18
    v_lshlrev_b32 v62, 16, v19
    v_and_b32 v63, 0xffff0000, v19
    v_lshlrev_b32 v64, 16, v20
    v_and_b32 v65, 0xffff0000, v20
    v_lshlrev_b32 v66, 16, v21
    v_and_b32 v67, 0xffff0000, v21
    v_lshlrev_b32 v68, 16, v22
    v_and_b32 v69, 0xffff0000, v22
    v_lshlrev_b32 v70, 16, v23
    v_and_b32 v71, 0xffff0000, v23
    v_lshlrev_b32 v72, 16, v24
    v_and_b32 v73, 0xffff0000, v24
    v_lshlrev_b32 v74, 16, v25
    v_and_b32 v75, 0xffff0000, v25
    v_lshlrev_b32 v76, 16, v26
    v_and_b32 v77, 0xffff0000, v26
    v_lshlrev_b32 v78, 16, v27
    v_and_b32 v79, 0xffff0000, v27
    v_lshlrev_b32 v80, 16, v28
    v_and_b32 v81, 0xffff0000, v28
    v_lshlrev_b32 v82, 16, v29
    v_and_b32 v83, 0xffff0000, v29
    v_lshlrev_b32 v84, 16, v30
    v_and_b32 v85, 0xffff0000, v30
    v_lshlrev_b32 v86, 16, v31
    v_and_b32 v87, 0xffff0000, v31
    v_lshlrev_b32 v88, 16, v32
    v_and_b32 v89, 0xffff0000, v32
    v_lshlrev_b32 v90, 16, v33
    v_and_b32 v91, 0xffff0000, v33
    v_lshlrev_b32 v92, 16, v34
    v_and_b32 v93, 0xffff0000, v34
    v_lshlrev_b32 v94, 16, v35
    v_and_b32 v95, 0xffff0000, v35
    v_lshlrev_b32 v96, 16, v36
    v_and_b32 v97, 0xffff0000, v36
    v_lshlrev_b32 v98, 16, v37
    v_and_b32 v99, 0xffff0000, v37
    v_lshlrev_b32 v100, 16, v38
    v_and_b32 v101, 0xffff0000, v38
    v_lshlrev_b32 v102, 16, v39
    v_and_b32 v103, 0xffff0000, v39
    v_pk_mul_f32 v[40:41], v[40:41], v[110:111] op_sel_hi:[1,0]
    v_pk_mul_f32 v[42:43], v[42:43], v[110:111] op_sel_hi:[1,0]
    v_pk_mul_f32 v[44:45], v[44:45], v[110:111] op_sel_hi:[1,0]
    v_pk_mul_f32 v[46:47], v[46:47], v[110:111] op_sel_hi:[1,0]
    v_pk_mul_f32 v[48:49], v[48:49], v[110:111] op_sel_hi:[1,0]
    v_pk_mul_f32 v[50:51], v[50:51], v[110:111] op_sel_hi:[1,0]
    v_pk_mul_f32 v[52:53], v[52:53], v[110:111] op_sel_hi:[1,0]
    v_pk_mul_f32 v[54:55], v[54:55], v[110:111] op_sel_hi:[1,0]
    v_pk_mul_f32 v[56:57], v[56:57], v[110:111] op_sel_hi:[1,0]
    v_pk_mul_f32 v[58:59], v[58:59], v[110:111] op_sel_hi:[1,0]
    v_pk_mul_f32 v[60:61], v[60:61], v[110:111] op_sel_hi:[1,0]
    v_pk_mul_f32 v[62:63], v[62:63], v[110:111] op_sel_hi:[1,0]
    v_pk_mul_f32 v[64:65], v[64:65], v[110:111] op_sel_hi:[1,0]
    v_pk_mul_f32 v[66:67], v[66:67], v[110:111] op_sel_hi:[1,0]
    v_pk_mul_f32 v[68:69], v[68:69], v[110:111] op_sel_hi:[1,0]
    v_pk_mul_f32 v[70:71], v[70:71], v[110:111] op_sel_hi:[1,0]
    v_pk_mul_f32 v[72:73], v[72:73], v[110:111] op_sel_hi:[1,0]
    v_pk_mul_f32 v[74:75], v[74:75], v[110:111] op_sel_hi:[1,0]
    v_pk_mul_f32 v[76:77], v[76:77], v[110:111] op_sel_hi:[1,0]
    v_pk_mul_f32 v[78:79], v[78:79], v[110:111] op_sel_hi:[1,0]
    v_pk_mul_f32 v[80:81], v[80:81], v[110:111] op_sel_hi:[1,0]
    v_pk_mul_f32 v[82:83], v[82:83], v[110:111] op_sel_hi:[1,0]
    v_pk_mul_f32 v[84:85], v[84:85], v[110:111] op_sel_hi:[1,0]
    v_pk_mul_f32 v[86:87], v[86:87], v[110:111] op_sel_hi:[1,0]
    v_pk_mul_f32 v[88:89], v[88:89], v[110:111] op_sel_hi:[1,0]
    v_pk_mul_f32 v[90:91], v[90:91], v[110:111] op_sel_hi:[1,0]
    v_pk_mul_f32 v[92:93], v[92:93], v[110:111] op_sel_hi:[1,0]
    v_pk_mul_f32 v[94:95], v[94:95], v[110:111] op_sel_hi:[1,0]
    v_pk_mul_f32 v[96:97], v[96:97], v[110:111] op_sel_hi:[1,0]
    v_pk_mul_f32 v[98:99], v[98:99], v[110:111] op_sel_hi:[1,0]
    v_pk_mul_f32 v[100:101], v[100:101], v[110:111] op_sel_hi:[1,0]
    v_pk_mul_f32 v[102:103], v[102:103], v[110:111] op_sel_hi:[1,0]
    v_cvt_pk_bf16_f32 v8, v40, v41
    v_cvt_pk_bf16_f32 v9, v42, v43
    v_cvt_pk_bf16_f32 v10, v44, v45
    v_cvt_pk_bf16_f32 v11, v46, v47
    v_cvt_pk_bf16_f32 v12, v48, v49
    v_cvt_pk_bf16_f32 v13, v50, v51
    v_cvt_pk_bf16_f32 v14, v52, v53
    v_cvt_pk_bf16_f32 v15, v54, v55
    v_cvt_pk_bf16_f32 v16, v56, v57
    v_cvt_pk_bf16_f32 v17, v58, v59
    v_cvt_pk_bf16_f32 v18, v60, v61
    v_cvt_pk_bf16_f32 v19, v62, v63
    v_cvt_pk_bf16_f32 v20, v64, v65
    v_cvt_pk_bf16_f32 v21, v66, v67
    v_cvt_pk_bf16_f32 v22, v68, v69
    v_cvt_pk_bf16_f32 v23, v70, v71
    v_cvt_pk_bf16_f32 v24, v72, v73
    v_cvt_pk_bf16_f32 v25, v74, v75
    v_cvt_pk_bf16_f32 v26, v76, v77
    v_cvt_pk_bf16_f32 v27, v78, v79
    v_cvt_pk_bf16_f32 v28, v80, v81
    v_cvt_pk_bf16_f32 v29, v82, v83
    v_cvt_pk_bf16_f32 v30, v84, v85
    v_cvt_pk_bf16_f32 v31, v86, v87
    v_cvt_pk_bf16_f32 v32, v88, v89
    v_cvt_pk_bf16_f32 v33, v90, v91
    v_cvt_pk_bf16_f32 v34, v92, v93
    v_cvt_pk_bf16_f32 v35, v94, v95
    v_cvt_pk_bf16_f32 v36, v96, v97
    v_cvt_pk_bf16_f32 v37, v98, v99
    v_cvt_pk_bf16_f32 v38, v100, v101
    v_cvt_pk_bf16_f32 v39, v102, v103
    s_waitcnt vmcnt(0)
    s_barrier
    ds_read_b64_tr_b16 v[40:41], v122 offset:0
    ds_read_b64_tr_b16 v[42:43], v122 offset:512
    ds_read_b64_tr_b16 v[44:45], v122 offset:2048
    ds_read_b64_tr_b16 v[46:47], v122 offset:2560
    ds_read_b64_tr_b16 v[48:49], v122 offset:4096
    ds_read_b64_tr_b16 v[50:51], v122 offset:4608
    ds_read_b64_tr_b16 v[52:53], v122 offset:6144
    ds_read_b64_tr_b16 v[54:55], v122 offset:6656
    ds_read_b64_tr_b16 v[56:57], v122 offset:8192
    ds_read_b64_tr_b16 v[58:59], v122 offset:8704
    ds_read_b64_tr_b16 v[60:61], v122 offset:10240
    ds_read_b64_tr_b16 v[62:63], v122 offset:10752
    ds_read_b64_tr_b16 v[64:65], v122 offset:12288
    ds_read_b64_tr_b16 v[66:67], v122 offset:12800
    ds_read_b64_tr_b16 v[68:69], v122 offset:14336
    ds_read_b64_tr_b16 v[70:71], v122 offset:14848
    ds_read_b64_tr_b16 v[72:73], v122 offset:16384
    ds_read_b64_tr_b16 v[74:75], v122 offset:16896
    ds_read_b64_tr_b16 v[76:77], v122 offset:18432
    ds_read_b64_tr_b16 v[78:79], v122 offset:18944
    ds_read_b64_tr_b16 v[80:81], v122 offset:20480
    ds_read_b64_tr_b16 v[82:83], v122 offset:20992
    ds_read_b64_tr_b16 v[84:85], v122 offset:22528
    ds_read_b64_tr_b16 v[86:87], v122 offset:23040
    ds_read_b64_tr_b16 v[88:89], v122 offset:24576
    ds_read_b64_tr_b16 v[90:91], v122 offset:25088
    ds_read_b64_tr_b16 v[92:93], v122 offset:26624
    ds_read_b64_tr_b16 v[94:95], v122 offset:27136
    ds_read_b64_tr_b16 v[96:97], v122 offset:28672
    ds_read_b64_tr_b16 v[98:99], v122 offset:29184
    ds_read_b64_tr_b16 v[100:101], v122 offset:30720
    ds_read_b64_tr_b16 v[102:103], v122 offset:31232
    s_and_b32 s41, s3, 3
    s_lshl_b32 s41, s41, 3
    v_add_u32 v4, s41, v4
    v_xor_b32 v4, v4, v5
    v_lshlrev_b32 v4, 4, v4
    v_lshrrev_b32 v7, 1, v5
    v_lshl_add_u32 v4, v7, 10, v4
    v_and_b32 v7, 1, v5
    v_lshl_add_u32 v4, v7, 9, v4
    s_lshl_b32 s41, s40, 15
    v_add_u32 v4, s41, v4
    v_xor_b32 v7, v2, v3
    v_lshlrev_b32 v7, 4, v7
    v_lshl_add_u32 v7, v3, 9, v7
    s_lshl_b32 s41, s38, 15
    s_lshl_b32 s42, s40, 14
    s_add_u32 s41, s41, s42
    v_add_u32 v120, s41, v7
    v_xor_b32 v121, 32, v120
    v_xor_b32 v122, 64, v120
    v_xor_b32 v123, 96, v120
    s_waitcnt lgkmcnt(0)
    s_barrier
    ds_write_b128 v4, v[8:11] offset:0
    ds_write_b128 v4, v[12:15] offset:4096
    ds_write_b128 v4, v[16:19] offset:8192
    ds_write_b128 v4, v[20:23] offset:12288
    ds_write_b128 v4, v[24:27] offset:16384
    ds_write_b128 v4, v[28:31] offset:20480
    ds_write_b128 v4, v[32:35] offset:24576
    ds_write_b128 v4, v[36:39] offset:28672
    s_waitcnt lgkmcnt(0)
    s_barrier
m_qproj:
    ds_read_b128 v[8:11], v120 offset:0
    ds_read_b128 v[12:15], v121 offset:1024
    ds_read_b128 v[16:19], v122 offset:2048
    ds_read_b128 v[20:23], v123 offset:3072
    s_waitcnt lgkmcnt(3)
    v_mfma_f32_32x32x16_bf16 v[104:119], v[40:43], v[8:11], 0
    ds_read_b128 v[8:11], v120 offset:4096
    s_waitcnt lgkmcnt(3)
    v_mfma_f32_32x32x16_bf16 v[104:119], v[44:47], v[12:15], v[104:119]
    ds_read_b128 v[12:15], v121 offset:5120
    s_waitcnt lgkmcnt(3)
    v_mfma_f32_32x32x16_bf16 v[104:119], v[48:51], v[16:19], v[104:119]
    ds_read_b128 v[16:19], v122 offset:6144
    s_waitcnt lgkmcnt(3)
    v_mfma_f32_32x32x16_bf16 v[104:119], v[52:55], v[20:23], v[104:119]
    ds_read_b128 v[20:23], v123 offset:7168
    s_waitcnt lgkmcnt(3)
    v_mfma_f32_32x32x16_bf16 v[104:119], v[56:59], v[8:11], v[104:119]
    ds_read_b128 v[8:11], v120 offset:8192
    s_waitcnt lgkmcnt(3)
    v_mfma_f32_32x32x16_bf16 v[104:119], v[60:63], v[12:15], v[104:119]
    ds_read_b128 v[12:15], v121 offset:9216
    s_waitcnt lgkmcnt(3)
    v_mfma_f32_32x32x16_bf16 v[104:119], v[64:67], v[16:19], v[104:119]
    ds_read_b128 v[16:19], v122 offset:10240
    s_waitcnt lgkmcnt(3)
    v_mfma_f32_32x32x16_bf16 v[104:119], v[68:71], v[20:23], v[104:119]
    ds_read_b128 v[20:23], v123 offset:11264
    s_waitcnt lgkmcnt(3)
    v_mfma_f32_32x32x16_bf16 v[104:119], v[72:75], v[8:11], v[104:119]
    ds_read_b128 v[8:11], v120 offset:12288
    s_waitcnt lgkmcnt(3)
    v_mfma_f32_32x32x16_bf16 v[104:119], v[76:79], v[12:15], v[104:119]
    ds_read_b128 v[12:15], v121 offset:13312
    s_waitcnt lgkmcnt(3)
    v_mfma_f32_32x32x16_bf16 v[104:119], v[80:83], v[16:19], v[104:119]
    ds_read_b128 v[16:19], v122 offset:14336
    s_waitcnt lgkmcnt(3)
    v_mfma_f32_32x32x16_bf16 v[104:119], v[84:87], v[20:23], v[104:119]
    ds_read_b128 v[20:23], v123 offset:15360
    s_waitcnt lgkmcnt(3)
    v_mfma_f32_32x32x16_bf16 v[104:119], v[88:91], v[8:11], v[104:119]
    s_waitcnt lgkmcnt(2)
    v_mfma_f32_32x32x16_bf16 v[104:119], v[92:95], v[12:15], v[104:119]
    s_waitcnt lgkmcnt(1)
    v_mfma_f32_32x32x16_bf16 v[104:119], v[96:99], v[16:19], v[104:119]
    s_waitcnt lgkmcnt(0)
    v_mfma_f32_32x32x16_bf16 v[104:119], v[100:103], v[20:23], v[104:119]
    s_barrier
    s_nop 7
    s_lshl_b32 s41, s3, 11
    s_add_u32 s41, s41, 65536
    v_add_u32 v7, s41, v6
    s_xor_b32 s41, s41, 8192
    v_add_u32 v4, s41, v6
    s_cmp_eq_u32 s40, 0
    s_cbranch_scc1 m_nosw
    v_swap_b32 v104, v112
    v_swap_b32 v105, v113
    v_swap_b32 v106, v114
    v_swap_b32 v107, v115
    v_swap_b32 v108, v116
    v_swap_b32 v109, v117
    v_swap_b32 v110, v118
    v_swap_b32 v111, v119
m_nosw:
    ds_write_b128 v7, v[112:115]
    ds_write_b128 v7, v[116:119] offset:1024
    v_mov_b32 v5, v4
    s_and_b32 s49, s2, 7
    s_lshl_b32 s49, s49, 10
    s_add_u32 s49, s49, 3162112
    s_waitcnt lgkmcnt(0)
    s_add_u32 s24, s12, 2097152
    s_addc_u32 s25, s13, 0
    s_and_b32 s25, s25, 0xffff
    s_mov_b32 s26, 131328
    s_mov_b32 s27, 0x00020000
    s_cmp_lg_u32 s3, 0
    s_cbranch_scc1 m_polledkv_19
    v_readfirstlane_b32 s68, v124
    v_readfirstlane_b32 s69, v125
    s_or_b32 s46, s68, s69
    s_cmp_lg_u32 s46, 0
    s_cbranch_scc1 m_eok_20
    v_mov_b32 v126, 0
m_ep_21:
    global_load_dwordx2 v[124:125], v126, s[14:15] sc1
    s_waitcnt vmcnt(0)
    v_readfirstlane_b32 s68, v124
    v_readfirstlane_b32 s69, v125
    s_or_b32 s46, s68, s69
    s_cmp_eq_u32 s46, 0
    s_cbranch_scc1 m_ep_21
m_eok_20:
    v_add_u32 v4, s49, v6
m_pollkv_18:
    global_load_dwordx4 v[124:127], v4, s[12:13] sc1
    s_waitcnt vmcnt(0)
    v_cmp_ne_u64 vcc, s[68:69], v[124:125]
    v_cmp_ne_u64 s[46:47], s[68:69], v[126:127]
    s_or_b64 vcc, vcc, s[46:47]
    s_cmp_eq_u64 vcc, 0
    s_cbranch_scc1 m_polledkv_19
    s_sleep 3
    s_branch m_pollkv_18
m_polledkv_19:
    s_barrier
    s_lshl_b32 s39, s39, 1
    s_add_u32 s39, s39, s40
    s_lshl_b32 s40, s3, 11
    s_add_u32 m0, s40, 0
    s_add_u32 s41, s40, 0
    buffer_load_dwordx4 v6, s[24:27], s41 offen lds
    s_add_u32 m0, s40, 1024
    s_add_u32 s41, s40, 1024
    buffer_load_dwordx4 v6, s[24:27], s41 offen lds
    v_lshlrev_b32 v7, 2, v1
    s_mov_b32 s41, 131072
    buffer_load_dword v8, v7, s[24:27], s41 offen
    s_add_u32 m0, s40, 16384
    s_add_u32 s41, s40, 16384
    buffer_load_dwordx4 v6, s[24:27], s41 offen lds
    s_add_u32 m0, s40, 17408
    s_add_u32 s41, s40, 17408
    buffer_load_dwordx4 v6, s[24:27], s41 offen lds
    s_add_u32 m0, s40, 32768
    s_add_u32 s41, s40, 32768
    buffer_load_dwordx4 v6, s[24:27], s41 offen lds
    s_add_u32 m0, s40, 33792
    s_add_u32 s41, s40, 33792
    buffer_load_dwordx4 v6, s[24:27], s41 offen lds
    s_add_u32 m0, s40, 49152
    s_add_u32 s41, s40, 49152
    buffer_load_dwordx4 v6, s[24:27], s41 offen lds
    s_add_u32 m0, s40, 50176
    s_add_u32 s41, s40, 50176
    buffer_load_dwordx4 v6, s[24:27], s41 offen lds
    ds_read_b128 v[40:43], v5
    ds_read_b128 v[44:47], v5 offset:1024
    s_waitcnt lgkmcnt(0)
    v_add_f32 v104, v104, v40
    v_add_f32 v105, v105, v41
    v_add_f32 v106, v106, v42
    v_add_f32 v107, v107, v43
    v_add_f32 v108, v108, v44
    v_add_f32 v109, v109, v45
    v_add_f32 v110, v110, v46
    v_add_f32 v111, v111, v47
    s_mov_b32 s41, 1052289595
    v_mul_f32 v104, s41, v104
    v_mul_f32 v105, s41, v105
    v_mul_f32 v106, s41, v106
    v_mul_f32 v107, s41, v107
    v_mul_f32 v108, s41, v108
    v_mul_f32 v109, s41, v109
    v_mul_f32 v110, s41, v110
    v_mul_f32 v111, s41, v111
    v_cvt_pk_bf16_f32 v88, v104, v105
    v_cvt_pk_bf16_f32 v89, v106, v107
    v_cvt_pk_bf16_f32 v90, v108, v109
    v_cvt_pk_bf16_f32 v91, v110, v111
    s_add_u32 s28, s12, 6291456
    s_addc_u32 s29, s13, 0
    s_and_b32 s29, s29, 0xffff
    s_mov_b32 s30, 9437184
    s_mov_b32 s31, 0x00020000
    s_mov_b32 s60, 0x0000ffff
    s_mov_b32 s61, 0x0000ffff
    v_mov_b32 v120, v6
    v_and_b32 v11, 15, v1
    v_lshlrev_b32 v11, 4, v11
    v_lshl_add_u32 v121, v3, 8, v11
    v_mov_b32 v15, 0x3f803f80
    v_cmp_eq_u32 vcc, 16, v2
    s_mov_b32 s50, 0
    s_mov_b32 s51, 16384
    s_mov_b32 s52, 0
    v_mov_b32 v13, 0
    v_cndmask_b32 v100, 0, v15, vcc
    v_cndmask_b32 v101, 0, v15, vcc
    v_cndmask_b32 v102, 0, v15, vcc
    v_cndmask_b32 v103, 0, v15, vcc
    v_cndmask_b32 v104, 0, v15, vcc
    v_cndmask_b32 v105, 0, v15, vcc
    v_cndmask_b32 v106, 0, v15, vcc
    v_cndmask_b32 v107, 0, v15, vcc
    v_cndmask_b32 v108, 0, v15, vcc
    v_cndmask_b32 v109, 0, v15, vcc
    v_cndmask_b32 v110, 0, v15, vcc
    v_cndmask_b32 v111, 0, v15, vcc
    v_cndmask_b32 v112, 0, v15, vcc
    v_cndmask_b32 v113, 0, v15, vcc
    v_cndmask_b32 v114, 0, v15, vcc
    v_cndmask_b32 v115, 0, v15, vcc
    v_dot2c_f32_bf16 v13, v88, v88
    v_dot2c_f32_bf16 v13, v89, v89
    v_dot2c_f32_bf16 v13, v90, v90
    v_dot2c_f32_bf16 v13, v91, v91
    v_mov_b32 v48, 0
    v_mov_b32 v49, 0
    v_mov_b32 v50, 0
    v_mov_b32 v51, 0
    v_mov_b32 v52, 0
    v_mov_b32 v53, 0
    v_mov_b32 v54, 0
    v_mov_b32 v55, 0
    v_mov_b32 v56, 0
    v_mov_b32 v57, 0
    v_mov_b32 v58, 0
    v_mov_b32 v59, 0
    v_mov_b32 v60, 0
    v_mov_b32 v61, 0
    v_mov_b32 v62, 0
    v_mov_b32 v63, 0
    v_mov_b32 v80, 0
    v_mov_b32 v81, 0
    v_mov_b32 v82, 0
    v_mov_b32 v83, 0
    v_mov_b32 v84, 0
    v_mov_b32 v85, 0
    v_mov_b32 v86, 0
    v_mov_b32 v87, 0
    v_add_u32 v116, s50, v120
    v_add_u32 v118, s50, v121
    v_add_u32 v117, s51, v120
    v_add_u32 v119, s51, v121
    v_mov_b32 v15, v13
    s_nop 1
    v_permlane32_swap_b32 v13, v15
    v_add_f32 v13, v13, v15
    s_waitcnt vmcnt(6)
    s_barrier
    s_add_u32 m0, s40, 65536
    s_add_u32 s41, s40, 65536
    buffer_load_dwordx4 v6, s[24:27], s41 offen lds
    s_add_u32 m0, s40, 66560
    s_add_u32 s41, s40, 66560
    buffer_load_dwordx4 v6, s[24:27], s41 offen lds
    ds_read_b128 v[92:95], v116 offset:0
    ds_read_b128 v[96:99], v116 offset:2048
    s_mov_b64 exec, s[60:61]
    ds_read_b128 v[100:103], v118 offset:1024
    ds_read_b128 v[104:107], v118 offset:1536
    s_mov_b64 exec, -1
    s_nop 1
    v_max_f32_dpp v8, v8, v8 row_shr:1 row_mask:0xf bank_mask:0xf
    s_nop 1
    v_max_f32_dpp v8, v8, v8 row_shr:2 row_mask:0xf bank_mask:0xf
    s_nop 1
    v_max_f32_dpp v8, v8, v8 row_shr:4 row_mask:0xf bank_mask:0xf
    s_nop 1
    v_max_f32_dpp v8, v8, v8 row_shr:8 row_mask:0xf bank_mask:0xf
    s_nop 1
    v_readlane_b32 s44, v8, 15
    v_readlane_b32 s45, v8, 31
    v_readlane_b32 s46, v8, 47
    v_readlane_b32 s47, v8, 63
    s_nop 1
    v_mov_b32 v8, s44
    v_max_f32 v8, s45, v8
    v_max_f32 v8, s46, v8
    v_max_f32 v8, s47, v8
    s_nop 0
    v_readfirstlane_b32 s62, v8
    s_nop 1
    v_mul_f32 v13, s62, v13
    v_sqrt_f32 v13, v13
    s_nop 0
    v_mul_f32 v13, 0x3f828f5c, v13
    v_cmp_lt_f32 vcc, 0x42200000, v13
    s_cmp_lg_u64 vcc, 0
    s_cbranch_scc0 m_fast
    v_mov_b32 v13, 0xff800000
    s_mov_b32 s41, 0
m_slow:
    buffer_load_dwordx4 v[80:83], v6, s[24:27], s41 offen
    s_waitcnt vmcnt(0)
    v_mfma_f32_32x32x16_bf16 v[16:31], v[80:83], v[88:91], 0
    s_nop 15
    s_nop 7
    v_max3_f32 v13, v16, v17, v13
    v_max3_f32 v13, v18, v19, v13
    v_max3_f32 v13, v20, v21, v13
    v_max3_f32 v13, v22, v23, v13
    v_max3_f32 v13, v24, v25, v13
    v_max3_f32 v13, v26, v27, v13
    v_max3_f32 v13, v28, v29, v13
    v_max3_f32 v13, v30, v31, v13
    s_add_u32 s41, s41, 2048
    s_cmp_lt_u32 s41, 131072
    s_cbranch_scc1 m_slow
    v_mov_b32 v15, v13
    s_nop 1
    v_permlane32_swap_b32 v13, v15
    v_max_f32 v13, v13, v15
    v_mov_b32 v80, 0
    v_mov_b32 v81, 0
    v_mov_b32 v82, 0
    v_mov_b32 v83, 0
m_fast:
    v_sub_f32 v64, 0, v13
    v_sub_f32 v65, 0, v13
    v_sub_f32 v66, 0, v13
    v_sub_f32 v67, 0, v13
    v_sub_f32 v68, 0, v13
    v_sub_f32 v69, 0, v13
    v_sub_f32 v70, 0, v13
    v_sub_f32 v71, 0, v13
    v_sub_f32 v72, 0, v13
    v_sub_f32 v73, 0, v13
    v_sub_f32 v74, 0, v13
    v_sub_f32 v75, 0, v13
    v_sub_f32 v76, 0, v13
    v_sub_f32 v77, 0, v13
    v_sub_f32 v78, 0, v13
    v_sub_f32 v79, 0, v13
    s_waitcnt lgkmcnt(0)
    s_nop 1
    v_mfma_f32_32x32x16_bf16 v[16:31], v[92:95], v[88:91], v[64:79]
    s_nop 15
.p2align 6
m_loop:
    v_exp_f32 v16, v16
    v_exp_f32 v17, v17
    v_mfma_f32_32x32x16_bf16 v[48:63], v[112:115], v[84:87], v[48:63]
    v_exp_f32 v18, v18
    v_exp_f32 v19, v19
    v_exp_f32 v20, v20
    v_exp_f32 v21, v21
    s_waitcnt lgkmcnt(0)
    v_mfma_f32_32x32x16_bf16 v[32:47], v[96:99], v[88:91], v[64:79]
    ds_read_b128 v[92:95], v116 offset:4096
    s_mov_b64 exec, s[60:61]
    ds_read_b128 v[108:111], v118 offset:3072
    ds_read_b128 v[112:115], v118 offset:3584
    s_mov_b64 exec, -1
    v_exp_f32 v22, v22
    v_exp_f32 v23, v23
    v_cvt_pk_bf16_f32 v80, v16, v17
    v_cvt_pk_bf16_f32 v81, v18, v19
    v_cvt_pk_bf16_f32 v82, v20, v21
    v_cvt_pk_bf16_f32 v83, v22, v23
    v_exp_f32 v24, v24
    v_exp_f32 v25, v25
    v_mfma_f32_32x32x16_bf16 v[48:63], v[100:103], v[80:83], v[48:63]
    v_exp_f32 v26, v26
    v_exp_f32 v27, v27
    v_exp_f32 v28, v28
    v_exp_f32 v29, v29
    v_exp_f32 v30, v30
    v_exp_f32 v31, v31
    v_cvt_pk_bf16_f32 v84, v24, v25
    v_cvt_pk_bf16_f32 v85, v26, v27
    v_cvt_pk_bf16_f32 v86, v28, v29
    v_cvt_pk_bf16_f32 v87, v30, v31
    v_exp_f32 v32, v32
    v_exp_f32 v33, v33
    v_mfma_f32_32x32x16_bf16 v[48:63], v[104:107], v[84:87], v[48:63]
    v_exp_f32 v34, v34
    v_exp_f32 v35, v35
    v_exp_f32 v36, v36
    v_exp_f32 v37, v37
    s_waitcnt lgkmcnt(0)
    v_mfma_f32_32x32x16_bf16 v[16:31], v[92:95], v[88:91], v[64:79]
    ds_read_b128 v[96:99], v116 offset:6144
    s_mov_b64 exec, s[60:61]
    ds_read_b128 v[100:103], v118 offset:5120
    ds_read_b128 v[104:107], v118 offset:5632
    s_mov_b64 exec, -1
    v_exp_f32 v38, v38
    v_exp_f32 v39, v39
    v_cvt_pk_bf16_f32 v80, v32, v33
    v_cvt_pk_bf16_f32 v81, v34, v35
    v_cvt_pk_bf16_f32 v82, v36, v37
    v_cvt_pk_bf16_f32 v83, v38, v39
    v_exp_f32 v40, v40
    v_exp_f32 v41, v41
    v_mfma_f32_32x32x16_bf16 v[48:63], v[108:111], v[80:83], v[48:63]
    v_exp_f32 v42, v42
    v_exp_f32 v43, v43
    v_exp_f32 v44, v44
    v_exp_f32 v45, v45
    v_exp_f32 v46, v46
    v_exp_f32 v47, v47
    v_cvt_pk_bf16_f32 v84, v40, v41
    v_cvt_pk_bf16_f32 v85, v42, v43
    v_cvt_pk_bf16_f32 v86, v44, v45
    v_cvt_pk_bf16_f32 v87, v46, v47
    v_exp_f32 v16, v16
    v_exp_f32 v17, v17
    v_mfma_f32_32x32x16_bf16 v[48:63], v[112:115], v[84:87], v[48:63]
    v_exp_f32 v18, v18
    v_exp_f32 v19, v19
    v_exp_f32 v20, v20
    v_exp_f32 v21, v21
    s_waitcnt lgkmcnt(0)
    v_mfma_f32_32x32x16_bf16 v[32:47], v[96:99], v[88:91], v[64:79]
    ds_read_b128 v[92:95], v116 offset:8192
    s_mov_b64 exec, s[60:61]
    ds_read_b128 v[108:111], v118 offset:7168
    ds_read_b128 v[112:115], v118 offset:7680
    s_mov_b64 exec, -1
    v_exp_f32 v22, v22
    v_exp_f32 v23, v23
    v_cvt_pk_bf16_f32 v80, v16, v17
    v_cvt_pk_bf16_f32 v81, v18, v19
    v_cvt_pk_bf16_f32 v82, v20, v21
    v_cvt_pk_bf16_f32 v83, v22, v23
    v_exp_f32 v24, v24
    v_exp_f32 v25, v25
    v_mfma_f32_32x32x16_bf16 v[48:63], v[100:103], v[80:83], v[48:63]
    v_exp_f32 v26, v26
    v_exp_f32 v27, v27
    v_exp_f32 v28, v28
    v_exp_f32 v29, v29
    v_exp_f32 v30, v30
    v_exp_f32 v31, v31
    v_cvt_pk_bf16_f32 v84, v24, v25
    v_cvt_pk_bf16_f32 v85, v26, v27
    v_cvt_pk_bf16_f32 v86, v28, v29
    v_cvt_pk_bf16_f32 v87, v30, v31
    v_exp_f32 v32, v32
    v_exp_f32 v33, v33
    v_mfma_f32_32x32x16_bf16 v[48:63], v[104:107], v[84:87], v[48:63]
    v_exp_f32 v34, v34
    v_exp_f32 v35, v35
    v_exp_f32 v36, v36
    v_exp_f32 v37, v37
    s_waitcnt lgkmcnt(0)
    v_mfma_f32_32x32x16_bf16 v[16:31], v[92:95], v[88:91], v[64:79]
    ds_read_b128 v[96:99], v116 offset:10240
    s_mov_b64 exec, s[60:61]
    ds_read_b128 v[100:103], v118 offset:9216
    ds_read_b128 v[104:107], v118 offset:9728
    s_mov_b64 exec, -1
    v_exp_f32 v38, v38
    v_exp_f32 v39, v39
    v_cvt_pk_bf16_f32 v80, v32, v33
    v_cvt_pk_bf16_f32 v81, v34, v35
    v_cvt_pk_bf16_f32 v82, v36, v37
    v_cvt_pk_bf16_f32 v83, v38, v39
    v_exp_f32 v40, v40
    v_exp_f32 v41, v41
    v_mfma_f32_32x32x16_bf16 v[48:63], v[108:111], v[80:83], v[48:63]
    v_exp_f32 v42, v42
    v_exp_f32 v43, v43
    v_exp_f32 v44, v44
    v_exp_f32 v45, v45
    v_exp_f32 v46, v46
    v_exp_f32 v47, v47
    v_cvt_pk_bf16_f32 v84, v40, v41
    v_cvt_pk_bf16_f32 v85, v42, v43
    v_cvt_pk_bf16_f32 v86, v44, v45
    v_cvt_pk_bf16_f32 v87, v46, v47
    v_exp_f32 v16, v16
    v_exp_f32 v17, v17
    v_mfma_f32_32x32x16_bf16 v[48:63], v[112:115], v[84:87], v[48:63]
    v_exp_f32 v18, v18
    v_exp_f32 v19, v19
    v_exp_f32 v20, v20
    v_exp_f32 v21, v21
    s_waitcnt lgkmcnt(0)
    v_mfma_f32_32x32x16_bf16 v[32:47], v[96:99], v[88:91], v[64:79]
    ds_read_b128 v[92:95], v116 offset:12288
    s_mov_b64 exec, s[60:61]
    ds_read_b128 v[108:111], v118 offset:11264
    ds_read_b128 v[112:115], v118 offset:11776
    s_mov_b64 exec, -1
    v_exp_f32 v22, v22
    v_exp_f32 v23, v23
    v_cvt_pk_bf16_f32 v80, v16, v17
    v_cvt_pk_bf16_f32 v81, v18, v19
    v_cvt_pk_bf16_f32 v82, v20, v21
    v_cvt_pk_bf16_f32 v83, v22, v23
    v_exp_f32 v24, v24
    v_exp_f32 v25, v25
    v_mfma_f32_32x32x16_bf16 v[48:63], v[100:103], v[80:83], v[48:63]
    v_exp_f32 v26, v26
    v_exp_f32 v27, v27
    v_exp_f32 v28, v28
    v_exp_f32 v29, v29
    v_exp_f32 v30, v30
    v_exp_f32 v31, v31
    v_cvt_pk_bf16_f32 v84, v24, v25
    v_cvt_pk_bf16_f32 v85, v26, v27
    v_cvt_pk_bf16_f32 v86, v28, v29
    v_cvt_pk_bf16_f32 v87, v30, v31
    v_exp_f32 v32, v32
    v_exp_f32 v33, v33
    v_mfma_f32_32x32x16_bf16 v[48:63], v[104:107], v[84:87], v[48:63]
    v_exp_f32 v34, v34
    v_exp_f32 v35, v35
    v_exp_f32 v36, v36
    v_exp_f32 v37, v37
    s_waitcnt lgkmcnt(0)
    v_mfma_f32_32x32x16_bf16 v[16:31], v[92:95], v[88:91], v[64:79]
    ds_read_b128 v[96:99], v116 offset:14336
    s_mov_b64 exec, s[60:61]
    ds_read_b128 v[100:103], v118 offset:13312
    ds_read_b128 v[104:107], v118 offset:13824
    s_mov_b64 exec, -1
    v_exp_f32 v38, v38
    v_exp_f32 v39, v39
    v_cvt_pk_bf16_f32 v80, v32, v33
    v_cvt_pk_bf16_f32 v81, v34, v35
    v_cvt_pk_bf16_f32 v82, v36, v37
    v_cvt_pk_bf16_f32 v83, v38, v39
    v_exp_f32 v40, v40
    v_exp_f32 v41, v41
    v_mfma_f32_32x32x16_bf16 v[48:63], v[108:111], v[80:83], v[48:63]
    v_exp_f32 v42, v42
    v_exp_f32 v43, v43
    v_exp_f32 v44, v44
    v_exp_f32 v45, v45
    v_exp_f32 v46, v46
    v_exp_f32 v47, v47
    v_cvt_pk_bf16_f32 v84, v40, v41
    v_cvt_pk_bf16_f32 v85, v42, v43
    v_cvt_pk_bf16_f32 v86, v44, v45
    v_cvt_pk_bf16_f32 v87, v46, v47
    v_exp_f32 v16, v16
    v_exp_f32 v17, v17
    v_mfma_f32_32x32x16_bf16 v[48:63], v[112:115], v[84:87], v[48:63]
    v_exp_f32 v18, v18
    v_exp_f32 v19, v19
    v_exp_f32 v20, v20
    v_exp_f32 v21, v21
    s_waitcnt vmcnt(0)
    s_barrier
    s_add_u32 s53, s52, -1
    s_cmp_gt_u32 s53, 2
    s_cbranch_scc1 m_noissue_22
    s_lshl_b32 s54, s53, 14
    s_add_u32 s54, s54, s40
    s_add_u32 s55, s52, 4
    s_lshl_b32 s55, s55, 14
    s_add_u32 s55, s55, s40
    s_add_u32 m0, s54, 0
    s_add_u32 s41, s55, 0
    buffer_load_dwordx4 v6, s[24:27], s41 offen lds
    s_add_u32 m0, s54, 1024
    s_add_u32 s41, s55, 1024
    buffer_load_dwordx4 v6, s[24:27], s41 offen lds
m_noissue_22:
    s_waitcnt lgkmcnt(0)
    v_mfma_f32_32x32x16_bf16 v[32:47], v[96:99], v[88:91], v[64:79]
    ds_read_b128 v[92:95], v117 offset:0
    s_mov_b64 exec, s[60:61]
    ds_read_b128 v[108:111], v118 offset:15360
    ds_read_b128 v[112:115], v118 offset:15872
    s_mov_b64 exec, -1
    v_exp_f32 v22, v22
    v_exp_f32 v23, v23
    v_cvt_pk_bf16_f32 v80, v16, v17
    v_cvt_pk_bf16_f32 v81, v18, v19
    v_cvt_pk_bf16_f32 v82, v20, v21
    v_cvt_pk_bf16_f32 v83, v22, v23
    v_exp_f32 v24, v24
    v_exp_f32 v25, v25
    v_mfma_f32_32x32x16_bf16 v[48:63], v[100:103], v[80:83], v[48:63]
    v_exp_f32 v26, v26
    v_exp_f32 v27, v27
    v_exp_f32 v28, v28
    v_exp_f32 v29, v29
    v_exp_f32 v30, v30
    v_exp_f32 v31, v31
    v_cvt_pk_bf16_f32 v84, v24, v25
    v_cvt_pk_bf16_f32 v85, v26, v27
    v_cvt_pk_bf16_f32 v86, v28, v29
    v_cvt_pk_bf16_f32 v87, v30, v31
    v_exp_f32 v32, v32
    v_exp_f32 v33, v33
    v_mfma_f32_32x32x16_bf16 v[48:63], v[104:107], v[84:87], v[48:63]
    v_exp_f32 v34, v34
    v_exp_f32 v35, v35
    v_exp_f32 v36, v36
    v_exp_f32 v37, v37
    s_waitcnt lgkmcnt(0)
    v_mfma_f32_32x32x16_bf16 v[16:31], v[92:95], v[88:91], v[64:79]
    ds_read_b128 v[96:99], v117 offset:2048
    s_mov_b64 exec, s[60:61]
    ds_read_b128 v[100:103], v119 offset:1024
    ds_read_b128 v[104:107], v119 offset:1536
    s_mov_b64 exec, -1
    v_exp_f32 v38, v38
    v_exp_f32 v39, v39
    v_cvt_pk_bf16_f32 v80, v32, v33
    v_cvt_pk_bf16_f32 v81, v34, v35
    v_cvt_pk_bf16_f32 v82, v36, v37
    v_cvt_pk_bf16_f32 v83, v38, v39
    v_exp_f32 v40, v40
    v_exp_f32 v41, v41
    v_mfma_f32_32x32x16_bf16 v[48:63], v[108:111], v[80:83], v[48:63]
    v_exp_f32 v42, v42
    v_exp_f32 v43, v43
    v_exp_f32 v44, v44
    v_exp_f32 v45, v45
    v_exp_f32 v46, v46
    v_exp_f32 v47, v47
    v_cvt_pk_bf16_f32 v84, v40, v41
    v_cvt_pk_bf16_f32 v85, v42, v43
    v_cvt_pk_bf16_f32 v86, v44, v45
    v_cvt_pk_bf16_f32 v87, v46, v47
    s_mov_b32 s50, s51
    s_add_u32 s51, s51, 16384
    s_cmp_ge_u32 s51, 81920
    s_cselect_b32 s51, 0, s51
    v_mov_b32 v116, v117
    v_mov_b32 v118, v119
    v_add_u32 v117, s51, v120
    v_add_u32 v119, s51, v121
    s_add_u32 s52, s52, 1
    s_cmp_lt_u32 s52, 8
    s_cbranch_scc1 m_loop
    v_mfma_f32_32x32x16_bf16 v[48:63], v[112:115], v[84:87], v[48:63]
    s_lshl_b32 s41, s37, 1
    s_add_u32 s41, s41, s38
    s_mul_i32 s41, s41, 147456
    s_lshl_b32 s42, s36, 12
    s_lshl_b32 s43, s39, 10
    s_add_u32 s41, s41, s42
    s_add_u32 s41, s41, s43
    s_nop 15
    v_mov_b32 v14, v56
    v_mov_b32 v15, v56
    s_nop 1
    v_permlane32_swap_b32 v15, v14
    v_rcp_f32 v15, v15
    s_nop 0
    v_mul_f32 v48, v48, v15
    v_mul_f32 v49, v49, v15
    v_mul_f32 v50, v50, v15
    v_mul_f32 v51, v51, v15
    v_mul_f32 v52, v52, v15
    v_mul_f32 v53, v53, v15
    v_mul_f32 v54, v54, v15
    v_mul_f32 v55, v55, v15
    v_cvt_pk_bf16_f32 v80, v48, v49
    v_cvt_pk_bf16_f32 v81, v50, v51
    v_cvt_pk_bf16_f32 v82, v52, v53
    v_cvt_pk_bf16_f32 v83, v54, v55
    buffer_store_dwordx4 v[80:83], v6, s[28:31], s41 offen sc1
    s_lshl_b32 s49, s37, 7
    s_lshl_b32 s41, s36, 3
    s_add_u32 s49, s49, s41
    s_add_u32 s49, s49, 3153920
    s_waitcnt vmcnt(0)
    s_barrier
    s_cmp_lg_u32 s3, 0
    s_cbranch_scc1 m_sig_23
    v_mov_b32 v4, s49
    v_mov_b32 v124, s68
    v_mov_b32 v125, s69
    s_mov_b64 s[46:47], exec
    s_mov_b64 exec, 1
    global_store_dwordx2 v4, v[124:125], s[12:13] sc1
    s_mov_b64 exec, s[46:47]
m_sig_23:
    s_endpgm
m_end:
    s_endpgm
.section .rodata,"a"
.p2align 6
.amdhsa_kernel parallel_sum__grouped_kv_mqa__glu_gated_geglu__prompt_kernel
  .amdhsa_next_free_vgpr 128
  .amdhsa_next_free_sgpr 100
  .amdhsa_accum_offset 128
  .amdhsa_group_segment_fixed_size 0
  .amdhsa_kernarg_size 96
  .amdhsa_user_sgpr_count 2
  .amdhsa_user_sgpr_kernarg_segment_ptr 1
  .amdhsa_system_sgpr_workgroup_id_x 1
.end_amdhsa_kernel
```
